```python
import torch

def _softmax(x, axis=-1):
    return torch.softmax(x, dim=axis)

def _gelu(x):
    return torch.nn.functional.gelu(x, approximate='tanh')

def _silu(x):
    return torch.nn.functional.silu(x)

def _sigmoid(x):
    return torch.sigmoid(x)

def _layernorm(x, axis=-1, eps=1e-05):
    m = x.mean(dim=axis, keepdim=True)
    v = x.var(dim=axis, keepdim=True, unbiased=False)
    return (x - m) / torch.sqrt(v + eps)

def _scatter_add(tgt, idx, src, axis=0):
    return tgt.clone().index_add_(axis, idx, src)

def _segment_sum(src, seg, n):
    out = torch.zeros((n,) + src.shape[1:], dtype=src.dtype)
    return out.index_add_(0, seg, src)

def _pad(x, pw):
    flat = tuple((v for pair in reversed(pw) for v in pair))
    return torch.nn.functional.pad(x, flat)
kernel_name = 'concat_heads__memory_aug_recurrent_mem_tr__compressed_kv_cla__prompt'

def setup_inputs():

    _w = lambda a: (lambda t: t.to(torch.bfloat16) if t.is_floating_point() else t)(torch.as_tensor(a))

    def _A_setup():
        B, S, Dm = (1, 2048, 448)
        H, Dh = (16, 256)
        M, seg = (8, 32)
        seg = min(seg, S)
        S = S // seg * seg
        return {'x': _w((lambda *s: torch.randn(*s, dtype=torch.bfloat16) * 0.05)(B, S, Dm)), 'mem0': _w((lambda *s: torch.randn(*s, dtype=torch.bfloat16) * 0.4)(B, M, Dm)), 'Wq': _w((lambda *s: torch.randn(*s, dtype=torch.bfloat16) * 6.4)(Dm, H, Dh) * Dm ** (-0.5)), 'Wk': _w((lambda *s: torch.randn(*s, dtype=torch.bfloat16) * 6.4)(Dm, H, Dh) * Dm ** (-0.5)), 'Wv': _w((lambda *s: torch.randn(*s, dtype=torch.bfloat16) * 0.4)(Dm, H, Dh) * Dm ** (-0.5)), 'Wo': _w((lambda *s: torch.randn(*s, dtype=torch.bfloat16) * 0.4)(H, Dh, Dm) * (H * Dh) ** (-0.5)), 'seg_len': seg}
    _A_in = _A_setup()

    def _B_setup():
        B, H, Sq, Sk, D, M = (1, 16, 2048, 2048, 256, 448)
        Dc = 4 * D
        return {'x': _w((lambda *s: torch.randn(*s, dtype=torch.bfloat16) * 1.6)(B, Sq, M)), 'c_kv': _w((lambda *s: torch.randn(*s, dtype=torch.bfloat16) * 0.2)(B, Sk, Dc)), 'w_q': _w((lambda *s: torch.randn(*s, dtype=torch.bfloat16) * 3.2)(M, H, D) * M ** (-0.5)), 'w_uk': _w((lambda *s: torch.randn(*s, dtype=torch.bfloat16) * 3.2)(Dc, H, D) * Dc ** (-0.5)), 'w_uv': _w((lambda *s: torch.randn(*s, dtype=torch.bfloat16) * 0.2)(Dc, H, D) * Dc ** (-0.5)), 'w_o': _w((lambda *s: torch.randn(*s, dtype=torch.bfloat16) * 0.2)(H, D, M) * (H * D) ** (-0.5))}
    _B_in = _B_setup()
    return {'A_x': _A_in['x'], 'A_mem0': _A_in['mem0'], 'A_Wq': _A_in['Wq'], 'A_Wk': _A_in['Wk'], 'A_Wv': _A_in['Wv'], 'A_Wo': _A_in['Wo'], 'A_seg_len': _A_in['seg_len'], 'B_x': _B_in['x'], 'B_c_kv': _B_in['c_kv'], 'B_w_q': _B_in['w_q'], 'B_w_uk': _B_in['w_uk'], 'B_w_uv': _B_in['w_uv'], 'B_w_o': _B_in['w_o']}

def reference(A_x, A_mem0, A_Wq, A_Wk, A_Wv, A_Wo, A_seg_len, B_x, B_c_kv, B_w_q, B_w_uk, B_w_uv, B_w_o):

    def _A_ref(x, mem0, Wq, Wk, Wv, Wo, seg_len):
        B, S, Dm = x.shape
        H, Dh = (Wq.shape[1], Wq.shape[2])
        M = mem0.shape[1]
        scale = Dh ** (-0.5)
        n_seg = S // seg_len
        L = M + seg_len
        idx = torch.arange(L)
        mask = (idx[:, None] < M) | (idx[:, None] >= idx[None, :])
        mem = mem0
        outs = []
        for s in range(n_seg):
            xs = x[:, s * seg_len:(s + 1) * seg_len, :].clone()
            h = torch.concatenate([mem, xs], axis=1)
            q = torch.einsum('btd,dhe->bhte', h, Wq)
            k = torch.einsum('btd,dhe->bhte', h, Wk)
            v = torch.einsum('btd,dhe->bhte', h, Wv)
            scores = torch.einsum('bhqe,bhke->bhqk', q, k) * scale
            scores = torch.where(mask[None, None], scores, -1000000000.0)
            p = _softmax(scores, axis=-1)
            o = torch.einsum('bhqk,bhke->bhqe', p, v)
            o = torch.einsum('bhte,hed->btd', o, Wo)
            mem = o[:, :M, :].clone()
            outs.append(o[:, M:, :])
        return torch.concatenate(outs, axis=1)

    def _B_ref(x, c_kv, w_q, w_uk, w_uv, w_o):
        B, Sq, M = (x.shape[0], x.shape[1], x.shape[2])
        Sk = c_kv.shape[1]
        H, D = (w_q.shape[1], w_q.shape[2])
        q = torch.einsum('bqm,mhd->bhqd', x, w_q)
        k = torch.einsum('bkc,chd->bhkd', c_kv, w_uk)
        v = torch.einsum('bkc,chd->bhkd', c_kv, w_uv)
        scores = torch.einsum('bhqd,bhkd->bhqk', q, k) * D ** (-0.5)
        off = Sk - Sq
        qi = torch.arange(Sq)[:, None]
        kj = torch.arange(Sk)[None, :]
        cmask = kj <= qi + off
        scores = torch.where(cmask[None, None], scores, -1000000000.0)
        p = _softmax(scores, axis=-1)
        ctx = torch.einsum('bhqk,bhkd->bhqd', p, v)
        return torch.einsum('bhqd,hdm->bqm', ctx, w_o)
    a = _A_ref(A_x, A_mem0, A_Wq, A_Wk, A_Wv, A_Wo, A_seg_len)
    b = _B_ref(B_x, B_c_kv, B_w_q, B_w_uk, B_w_uv, B_w_o)
    return torch.concatenate([a, b], axis=-1)
```

```asm
; @launch kernel=proj_kernel grid=(3136,1,1) block=(256,1,1) lds=77824
; @launch kernel=chain_kernel grid=(256,1,1) block=(256,1,1) lds=102144
; @launch kernel=attna_kernel grid=(512,1,1) block=(128,1,1) lds=141312
; @launch kernel=oproj_kernel grid=(128,1,1) block=(256,1,1) lds=77824
.amdgcn_target "amdgcn-amd-amdhsa--gfx950"
.text
.globl proj_kernel
.p2align 8
.type proj_kernel,@function
proj_kernel:
    s_cmp_ge_u32 s2, 3136
    s_cbranch_scc1 pjdone_1
    s_load_dwordx16 s[16:31], s[0:1], 0
    s_load_dwordx16 s[32:47], s[0:1], 64
    s_cmp_lt_u32 s2, 3072
    s_cbranch_scc1 pjnz_2
    s_sub_u32 s54, s2, 3072
    s_lshl_b32 s54, s54, 14
    s_add_u32 s54, s54, 146800640
    v_lshlrev_b32 v1, 4, v0
    v_add_u32 v1, s54, v1
    v_mov_b32 v4, 0
    v_mov_b32 v5, 0
    v_mov_b32 v6, 0
    v_mov_b32 v7, 0
    s_waitcnt lgkmcnt(0)
    global_store_dwordx4 v1, v[4:7], s[46:47] offset:0
    v_add_u32 v1, 4096, v1
    global_store_dwordx4 v1, v[4:7], s[46:47] offset:0
    v_add_u32 v1, 4096, v1
    global_store_dwordx4 v1, v[4:7], s[46:47] offset:0
    v_add_u32 v1, 4096, v1
    global_store_dwordx4 v1, v[4:7], s[46:47] offset:0
    v_add_u32 v1, 4096, v1
    s_branch pjdone_1
pjnz_2:
    s_lshr_b32 s54, s2, 9
    s_and_b32 s55, s2, 511
    s_and_b32 s56, s55, 31
    s_lshr_b32 s57, s55, 5
    s_waitcnt lgkmcnt(0)
    s_cmp_eq_u32 s54, 0
    s_cbranch_scc0 pjnx_4
    s_add_u32 s4, s16, 0
    s_addc_u32 s5, s17, 0
    s_mov_b32 s6, 1835008
    s_add_u32 s8, s20, 0
    s_addc_u32 s9, s21, 0
    s_mov_b32 s10, 3670016
    s_add_u32 s12, s46, 0
    s_addc_u32 s13, s47, 0
    s_mov_b32 s14, 50331648
    s_mov_b32 s48, 896
    s_mov_b32 s49, 8192
    s_mov_b32 s50, 24576
    s_mov_b32 s51, 7
    s_branch pjgo_3
pjnx_4:
    s_cmp_eq_u32 s54, 1
    s_cbranch_scc0 pjnx_5
    s_add_u32 s4, s16, 0
    s_addc_u32 s5, s17, 0
    s_mov_b32 s6, 1835008
    s_add_u32 s8, s22, 0
    s_addc_u32 s9, s23, 0
    s_mov_b32 s10, 3670016
    s_add_u32 s12, s46, 8192
    s_addc_u32 s13, s47, 0
    s_mov_b32 s14, 50323456
    s_mov_b32 s48, 896
    s_mov_b32 s49, 8192
    s_mov_b32 s50, 24576
    s_mov_b32 s51, 7
    s_branch pjgo_3
pjnx_5:
    s_cmp_eq_u32 s54, 2
    s_cbranch_scc0 pjnx_6
    s_add_u32 s4, s16, 0
    s_addc_u32 s5, s17, 0
    s_mov_b32 s6, 1835008
    s_add_u32 s8, s24, 0
    s_addc_u32 s9, s25, 0
    s_mov_b32 s10, 3670016
    s_add_u32 s12, s46, 16384
    s_addc_u32 s13, s47, 0
    s_mov_b32 s14, 50315264
    s_mov_b32 s48, 896
    s_mov_b32 s49, 8192
    s_mov_b32 s50, 24576
    s_mov_b32 s51, 7
    s_branch pjgo_3
pjnx_6:
    s_cmp_eq_u32 s54, 3
    s_cbranch_scc0 pjnx_7
    s_add_u32 s4, s30, 0
    s_addc_u32 s5, s31, 0
    s_mov_b32 s6, 1835008
    s_add_u32 s8, s34, 0
    s_addc_u32 s9, s35, 0
    s_mov_b32 s10, 3670016
    s_add_u32 s12, s46, 50331648
    s_addc_u32 s13, s47, 0
    s_mov_b32 s14, 16777216
    s_mov_b32 s48, 896
    s_mov_b32 s49, 8192
    s_mov_b32 s50, 8192
    s_mov_b32 s51, 7
    s_branch pjgo_3
pjnx_7:
    s_cmp_eq_u32 s54, 4
    s_cbranch_scc0 pjnx_8
    s_add_u32 s4, s32, 0
    s_addc_u32 s5, s33, 0
    s_mov_b32 s6, 4194304
    s_add_u32 s8, s36, 0
    s_addc_u32 s9, s37, 0
    s_mov_b32 s10, 8388608
    s_add_u32 s12, s46, 67108864
    s_addc_u32 s13, s47, 0
    s_mov_b32 s14, 33554432
    s_mov_b32 s48, 2048
    s_mov_b32 s49, 8192
    s_mov_b32 s50, 16384
    s_mov_b32 s51, 16
    s_branch pjgo_3
pjnx_8:
    s_cmp_eq_u32 s54, 5
    s_cbranch_scc0 pjnx_9
    s_add_u32 s4, s32, 0
    s_addc_u32 s5, s33, 0
    s_mov_b32 s6, 4194304
    s_add_u32 s8, s38, 0
    s_addc_u32 s9, s39, 0
    s_mov_b32 s10, 8388608
    s_add_u32 s12, s46, 67117056
    s_addc_u32 s13, s47, 0
    s_mov_b32 s14, 33546240
    s_mov_b32 s48, 2048
    s_mov_b32 s49, 8192
    s_mov_b32 s50, 16384
    s_mov_b32 s51, 16
    s_branch pjgo_3
pjnx_9:
    s_branch pjdone_1
pjgo_3:
    s_mov_b32 s7, 0x00020000
    s_mov_b32 s11, 0x00020000
    s_mov_b32 s15, 0x00020000
    v_lshrrev_b32 v1, 3, v0
    v_and_b32 v2, 7, v0
    s_lshl_b32 s58, s57, 7
    v_add_u32 v1, s58, v1
    v_mul_lo_u32 v1, v1, s48
    v_lshl_add_u32 v4, v2, 4, v1
    s_lshl_b32 s59, s48, 5
    v_add_u32 v5, s59, v4
    v_add_u32 v6, s59, v5
    v_add_u32 v7, s59, v6
    v_lshrrev_b32 v1, 3, v0
    v_mul_u32_u24 v1, 144, v1
    v_lshl_add_u32 v12, v2, 4, v1
    v_lshrrev_b32 v1, 4, v0
    v_and_b32 v2, 15, v0
    v_mul_lo_u32 v3, v1, s49
    v_lshl_add_u32 v3, v2, 4, v3
    s_lshl_b32 s59, s56, 8
    v_add_u32 v8, s59, v3
    s_lshl_b32 s59, s49, 4
    v_add_u32 v9, s59, v8
    v_add_u32 v10, s59, v9
    v_add_u32 v11, s59, v10
    v_mul_u32_u24 v1, 320, v1
    v_lshl_add_u32 v13, v2, 4, v1
    v_add_u32 v13, 18432, v13
    v_lshrrev_b32 v1, 6, v0
    v_and_b32 v2, 63, v0
    v_lshrrev_b32 v3, 1, v1
    v_and_b32 v1, 1, v1
    v_and_b32 v14, 31, v2
    v_lshl_add_u32 v14, v3, 6, v14
    v_mul_u32_u24 v14, 144, v14
    v_lshrrev_b32 v15, 5, v2
    v_lshl_add_u32 v14, v15, 4, v14
    v_and_b32 v16, 15, v2
    v_lshrrev_b32 v17, 2, v16
    v_lshl_add_u32 v17, v15, 3, v17
    v_mul_u32_u24 v17, 320, v17
    v_and_b32 v16, 3, v16
    v_lshlrev_b32 v16, 3, v16
    v_add_u32 v17, v17, v16
    v_bfe_u32 v16, v2, 4, 1
    v_lshl_add_u32 v17, v16, 5, v17
    v_lshl_add_u32 v17, v1, 7, v17
    v_add_u32 v17, 18432, v17
    v_and_b32 v18, 31, v2
    v_lshl_add_u32 v18, v3, 6, v18
    v_add_u32 v18, s58, v18
    v_mul_lo_u32 v18, v18, s50
    v_lshl_add_u32 v18, v15, 3, v18
    v_lshl_add_u32 v18, v1, 7, v18
    s_lshl_b32 s59, s56, 8
    v_add_u32 v18, s59, v18
    v_mov_b32 v64, 0
    v_mov_b32 v65, 0
    v_mov_b32 v66, 0
    v_mov_b32 v67, 0
    v_mov_b32 v68, 0
    v_mov_b32 v69, 0
    v_mov_b32 v70, 0
    v_mov_b32 v71, 0
    v_mov_b32 v72, 0
    v_mov_b32 v73, 0
    v_mov_b32 v74, 0
    v_mov_b32 v75, 0
    v_mov_b32 v76, 0
    v_mov_b32 v77, 0
    v_mov_b32 v78, 0
    v_mov_b32 v79, 0
    v_mov_b32 v80, 0
    v_mov_b32 v81, 0
    v_mov_b32 v82, 0
    v_mov_b32 v83, 0
    v_mov_b32 v84, 0
    v_mov_b32 v85, 0
    v_mov_b32 v86, 0
    v_mov_b32 v87, 0
    v_mov_b32 v88, 0
    v_mov_b32 v89, 0
    v_mov_b32 v90, 0
    v_mov_b32 v91, 0
    v_mov_b32 v92, 0
    v_mov_b32 v93, 0
    v_mov_b32 v94, 0
    v_mov_b32 v95, 0
    v_mov_b32 v96, 0
    v_mov_b32 v97, 0
    v_mov_b32 v98, 0
    v_mov_b32 v99, 0
    v_mov_b32 v100, 0
    v_mov_b32 v101, 0
    v_mov_b32 v102, 0
    v_mov_b32 v103, 0
    v_mov_b32 v104, 0
    v_mov_b32 v105, 0
    v_mov_b32 v106, 0
    v_mov_b32 v107, 0
    v_mov_b32 v108, 0
    v_mov_b32 v109, 0
    v_mov_b32 v110, 0
    v_mov_b32 v111, 0
    v_mov_b32 v112, 0
    v_mov_b32 v113, 0
    v_mov_b32 v114, 0
    v_mov_b32 v115, 0
    v_mov_b32 v116, 0
    v_mov_b32 v117, 0
    v_mov_b32 v118, 0
    v_mov_b32 v119, 0
    v_mov_b32 v120, 0
    v_mov_b32 v121, 0
    v_mov_b32 v122, 0
    v_mov_b32 v123, 0
    v_mov_b32 v124, 0
    v_mov_b32 v125, 0
    v_mov_b32 v126, 0
    v_mov_b32 v127, 0
    s_mov_b32 s52, 0
    s_mov_b32 s53, 0
    s_lshl_b32 s60, s49, 6
    buffer_load_dwordx4 v[32:35], v4, s[4:7], s52 offen
    buffer_load_dwordx4 v[36:39], v5, s[4:7], s52 offen
    buffer_load_dwordx4 v[40:43], v6, s[4:7], s52 offen
    buffer_load_dwordx4 v[44:47], v7, s[4:7], s52 offen
    buffer_load_dwordx4 v[48:51], v8, s[8:11], s53 offen
    buffer_load_dwordx4 v[52:55], v9, s[8:11], s53 offen
    buffer_load_dwordx4 v[56:59], v10, s[8:11], s53 offen
    buffer_load_dwordx4 v[60:63], v11, s[8:11], s53 offen
    s_add_u32 s52, s52, 128
    s_add_u32 s53, s53, s60
    s_waitcnt vmcnt(0)
    ds_write_b128 v12, v[32:35] offset:0
    ds_write_b128 v12, v[36:39] offset:4608
    ds_write_b128 v12, v[40:43] offset:9216
    ds_write_b128 v12, v[44:47] offset:13824
    ds_write_b128 v13, v[48:51] offset:0
    ds_write_b128 v13, v[52:55] offset:5120
    ds_write_b128 v13, v[56:59] offset:10240
    ds_write_b128 v13, v[60:63] offset:15360
    s_waitcnt lgkmcnt(0)
    s_barrier
pjloop_10:
    s_sub_u32 s51, s51, 1
    s_cmp_eq_u32 s51, 0
    s_cbranch_scc1 pjnol_11
    buffer_load_dwordx4 v[32:35], v4, s[4:7], s52 offen
    buffer_load_dwordx4 v[36:39], v5, s[4:7], s52 offen
    buffer_load_dwordx4 v[40:43], v6, s[4:7], s52 offen
    buffer_load_dwordx4 v[44:47], v7, s[4:7], s52 offen
    buffer_load_dwordx4 v[48:51], v8, s[8:11], s53 offen
    buffer_load_dwordx4 v[52:55], v9, s[8:11], s53 offen
    buffer_load_dwordx4 v[56:59], v10, s[8:11], s53 offen
    buffer_load_dwordx4 v[60:63], v11, s[8:11], s53 offen
    s_add_u32 s52, s52, 128
    s_add_u32 s53, s53, s60
pjnol_11:
    ds_read_b64_tr_b16 v[128:129], v17 offset:0
    ds_read_b64_tr_b16 v[130:131], v17 offset:1280
    ds_read_b64_tr_b16 v[132:133], v17 offset:64
    ds_read_b64_tr_b16 v[134:135], v17 offset:1344
    ds_read_b128 v[136:139], v14 offset:0
    ds_read_b128 v[140:143], v14 offset:4608
    ds_read_b64_tr_b16 v[144:145], v17 offset:5120
    ds_read_b64_tr_b16 v[146:147], v17 offset:6400
    ds_read_b64_tr_b16 v[148:149], v17 offset:5184
    ds_read_b64_tr_b16 v[150:151], v17 offset:6464
    ds_read_b128 v[152:155], v14 offset:32
    ds_read_b128 v[156:159], v14 offset:4640
    s_waitcnt lgkmcnt(6)
    v_mfma_f32_32x32x16_bf16 v[64:79], v[128:131], v[136:139], v[64:79]
    v_mfma_f32_32x32x16_bf16 v[80:95], v[128:131], v[140:143], v[80:95]
    v_mfma_f32_32x32x16_bf16 v[96:111], v[132:135], v[136:139], v[96:111]
    v_mfma_f32_32x32x16_bf16 v[112:127], v[132:135], v[140:143], v[112:127]
    ds_read_b64_tr_b16 v[128:129], v17 offset:10240
    ds_read_b64_tr_b16 v[130:131], v17 offset:11520
    ds_read_b64_tr_b16 v[132:133], v17 offset:10304
    ds_read_b64_tr_b16 v[134:135], v17 offset:11584
    ds_read_b128 v[136:139], v14 offset:64
    ds_read_b128 v[140:143], v14 offset:4672
    s_waitcnt lgkmcnt(6)
    v_mfma_f32_32x32x16_bf16 v[64:79], v[144:147], v[152:155], v[64:79]
    v_mfma_f32_32x32x16_bf16 v[80:95], v[144:147], v[156:159], v[80:95]
    v_mfma_f32_32x32x16_bf16 v[96:111], v[148:151], v[152:155], v[96:111]
    v_mfma_f32_32x32x16_bf16 v[112:127], v[148:151], v[156:159], v[112:127]
    ds_read_b64_tr_b16 v[144:145], v17 offset:15360
    ds_read_b64_tr_b16 v[146:147], v17 offset:16640
    ds_read_b64_tr_b16 v[148:149], v17 offset:15424
    ds_read_b64_tr_b16 v[150:151], v17 offset:16704
    ds_read_b128 v[152:155], v14 offset:96
    ds_read_b128 v[156:159], v14 offset:4704
    s_waitcnt lgkmcnt(6)
    v_mfma_f32_32x32x16_bf16 v[64:79], v[128:131], v[136:139], v[64:79]
    v_mfma_f32_32x32x16_bf16 v[80:95], v[128:131], v[140:143], v[80:95]
    v_mfma_f32_32x32x16_bf16 v[96:111], v[132:135], v[136:139], v[96:111]
    v_mfma_f32_32x32x16_bf16 v[112:127], v[132:135], v[140:143], v[112:127]
    s_waitcnt lgkmcnt(0)
    v_mfma_f32_32x32x16_bf16 v[64:79], v[144:147], v[152:155], v[64:79]
    v_mfma_f32_32x32x16_bf16 v[80:95], v[144:147], v[156:159], v[80:95]
    v_mfma_f32_32x32x16_bf16 v[96:111], v[148:151], v[152:155], v[96:111]
    v_mfma_f32_32x32x16_bf16 v[112:127], v[148:151], v[156:159], v[112:127]
    s_cmp_eq_u32 s51, 0
    s_cbranch_scc1 pj_epi
    s_waitcnt vmcnt(0)
    ds_write_b128 v12, v[32:35] offset:38912
    ds_write_b128 v12, v[36:39] offset:43520
    ds_write_b128 v12, v[40:43] offset:48128
    ds_write_b128 v12, v[44:47] offset:52736
    ds_write_b128 v13, v[48:51] offset:38912
    ds_write_b128 v13, v[52:55] offset:44032
    ds_write_b128 v13, v[56:59] offset:49152
    ds_write_b128 v13, v[60:63] offset:54272
    s_waitcnt lgkmcnt(0)
    s_barrier
    s_sub_u32 s51, s51, 1
    s_cmp_eq_u32 s51, 0
    s_cbranch_scc1 pjnol_12
    buffer_load_dwordx4 v[32:35], v4, s[4:7], s52 offen
    buffer_load_dwordx4 v[36:39], v5, s[4:7], s52 offen
    buffer_load_dwordx4 v[40:43], v6, s[4:7], s52 offen
    buffer_load_dwordx4 v[44:47], v7, s[4:7], s52 offen
    buffer_load_dwordx4 v[48:51], v8, s[8:11], s53 offen
    buffer_load_dwordx4 v[52:55], v9, s[8:11], s53 offen
    buffer_load_dwordx4 v[56:59], v10, s[8:11], s53 offen
    buffer_load_dwordx4 v[60:63], v11, s[8:11], s53 offen
    s_add_u32 s52, s52, 128
    s_add_u32 s53, s53, s60
pjnol_12:
    ds_read_b64_tr_b16 v[128:129], v17 offset:38912
    ds_read_b64_tr_b16 v[130:131], v17 offset:40192
    ds_read_b64_tr_b16 v[132:133], v17 offset:38976
    ds_read_b64_tr_b16 v[134:135], v17 offset:40256
    ds_read_b128 v[136:139], v14 offset:38912
    ds_read_b128 v[140:143], v14 offset:43520
    ds_read_b64_tr_b16 v[144:145], v17 offset:44032
    ds_read_b64_tr_b16 v[146:147], v17 offset:45312
    ds_read_b64_tr_b16 v[148:149], v17 offset:44096
    ds_read_b64_tr_b16 v[150:151], v17 offset:45376
    ds_read_b128 v[152:155], v14 offset:38944
    ds_read_b128 v[156:159], v14 offset:43552
    s_waitcnt lgkmcnt(6)
    v_mfma_f32_32x32x16_bf16 v[64:79], v[128:131], v[136:139], v[64:79]
    v_mfma_f32_32x32x16_bf16 v[80:95], v[128:131], v[140:143], v[80:95]
    v_mfma_f32_32x32x16_bf16 v[96:111], v[132:135], v[136:139], v[96:111]
    v_mfma_f32_32x32x16_bf16 v[112:127], v[132:135], v[140:143], v[112:127]
    ds_read_b64_tr_b16 v[128:129], v17 offset:49152
    ds_read_b64_tr_b16 v[130:131], v17 offset:50432
    ds_read_b64_tr_b16 v[132:133], v17 offset:49216
    ds_read_b64_tr_b16 v[134:135], v17 offset:50496
    ds_read_b128 v[136:139], v14 offset:38976
    ds_read_b128 v[140:143], v14 offset:43584
    s_waitcnt lgkmcnt(6)
    v_mfma_f32_32x32x16_bf16 v[64:79], v[144:147], v[152:155], v[64:79]
    v_mfma_f32_32x32x16_bf16 v[80:95], v[144:147], v[156:159], v[80:95]
    v_mfma_f32_32x32x16_bf16 v[96:111], v[148:151], v[152:155], v[96:111]
    v_mfma_f32_32x32x16_bf16 v[112:127], v[148:151], v[156:159], v[112:127]
    ds_read_b64_tr_b16 v[144:145], v17 offset:54272
    ds_read_b64_tr_b16 v[146:147], v17 offset:55552
    ds_read_b64_tr_b16 v[148:149], v17 offset:54336
    ds_read_b64_tr_b16 v[150:151], v17 offset:55616
    ds_read_b128 v[152:155], v14 offset:39008
    ds_read_b128 v[156:159], v14 offset:43616
    s_waitcnt lgkmcnt(6)
    v_mfma_f32_32x32x16_bf16 v[64:79], v[128:131], v[136:139], v[64:79]
    v_mfma_f32_32x32x16_bf16 v[80:95], v[128:131], v[140:143], v[80:95]
    v_mfma_f32_32x32x16_bf16 v[96:111], v[132:135], v[136:139], v[96:111]
    v_mfma_f32_32x32x16_bf16 v[112:127], v[132:135], v[140:143], v[112:127]
    s_waitcnt lgkmcnt(0)
    v_mfma_f32_32x32x16_bf16 v[64:79], v[144:147], v[152:155], v[64:79]
    v_mfma_f32_32x32x16_bf16 v[80:95], v[144:147], v[156:159], v[80:95]
    v_mfma_f32_32x32x16_bf16 v[96:111], v[148:151], v[152:155], v[96:111]
    v_mfma_f32_32x32x16_bf16 v[112:127], v[148:151], v[156:159], v[112:127]
    s_cmp_eq_u32 s51, 0
    s_cbranch_scc1 pj_epi
    s_waitcnt vmcnt(0)
    ds_write_b128 v12, v[32:35] offset:0
    ds_write_b128 v12, v[36:39] offset:4608
    ds_write_b128 v12, v[40:43] offset:9216
    ds_write_b128 v12, v[44:47] offset:13824
    ds_write_b128 v13, v[48:51] offset:0
    ds_write_b128 v13, v[52:55] offset:5120
    ds_write_b128 v13, v[56:59] offset:10240
    ds_write_b128 v13, v[60:63] offset:15360
    s_waitcnt lgkmcnt(0)
    s_barrier
    s_branch pjloop_10
pj_epi:
    s_nop 15
    v_cvt_pk_bf16_f32 v20, v64, v65
    v_cvt_pk_bf16_f32 v21, v66, v67
    buffer_store_dwordx2 v[20:21], v18, s[12:15], 0 offen offset:0
    s_nop 1
    v_cvt_pk_bf16_f32 v20, v68, v69
    v_cvt_pk_bf16_f32 v21, v70, v71
    buffer_store_dwordx2 v[20:21], v18, s[12:15], 0 offen offset:16
    s_nop 1
    v_cvt_pk_bf16_f32 v20, v72, v73
    v_cvt_pk_bf16_f32 v21, v74, v75
    buffer_store_dwordx2 v[20:21], v18, s[12:15], 0 offen offset:32
    s_nop 1
    v_cvt_pk_bf16_f32 v20, v76, v77
    v_cvt_pk_bf16_f32 v21, v78, v79
    buffer_store_dwordx2 v[20:21], v18, s[12:15], 0 offen offset:48
    s_nop 1
    v_cvt_pk_bf16_f32 v20, v80, v81
    v_cvt_pk_bf16_f32 v21, v82, v83
    s_lshl_b32 s59, s50, 5
    buffer_store_dwordx2 v[20:21], v18, s[12:15], s59 offen offset:0
    s_nop 1
    v_cvt_pk_bf16_f32 v20, v84, v85
    v_cvt_pk_bf16_f32 v21, v86, v87
    s_lshl_b32 s59, s50, 5
    buffer_store_dwordx2 v[20:21], v18, s[12:15], s59 offen offset:16
    s_nop 1
    v_cvt_pk_bf16_f32 v20, v88, v89
    v_cvt_pk_bf16_f32 v21, v90, v91
    s_lshl_b32 s59, s50, 5
    buffer_store_dwordx2 v[20:21], v18, s[12:15], s59 offen offset:32
    s_nop 1
    v_cvt_pk_bf16_f32 v20, v92, v93
    v_cvt_pk_bf16_f32 v21, v94, v95
    s_lshl_b32 s59, s50, 5
    buffer_store_dwordx2 v[20:21], v18, s[12:15], s59 offen offset:48
    s_nop 1
    v_cvt_pk_bf16_f32 v20, v96, v97
    v_cvt_pk_bf16_f32 v21, v98, v99
    buffer_store_dwordx2 v[20:21], v18, s[12:15], 0 offen offset:64
    s_nop 1
    v_cvt_pk_bf16_f32 v20, v100, v101
    v_cvt_pk_bf16_f32 v21, v102, v103
    buffer_store_dwordx2 v[20:21], v18, s[12:15], 0 offen offset:80
    s_nop 1
    v_cvt_pk_bf16_f32 v20, v104, v105
    v_cvt_pk_bf16_f32 v21, v106, v107
    buffer_store_dwordx2 v[20:21], v18, s[12:15], 0 offen offset:96
    s_nop 1
    v_cvt_pk_bf16_f32 v20, v108, v109
    v_cvt_pk_bf16_f32 v21, v110, v111
    buffer_store_dwordx2 v[20:21], v18, s[12:15], 0 offen offset:112
    s_nop 1
    v_cvt_pk_bf16_f32 v20, v112, v113
    v_cvt_pk_bf16_f32 v21, v114, v115
    s_lshl_b32 s59, s50, 5
    buffer_store_dwordx2 v[20:21], v18, s[12:15], s59 offen offset:64
    s_nop 1
    v_cvt_pk_bf16_f32 v20, v116, v117
    v_cvt_pk_bf16_f32 v21, v118, v119
    s_lshl_b32 s59, s50, 5
    buffer_store_dwordx2 v[20:21], v18, s[12:15], s59 offen offset:80
    s_nop 1
    v_cvt_pk_bf16_f32 v20, v120, v121
    v_cvt_pk_bf16_f32 v21, v122, v123
    s_lshl_b32 s59, s50, 5
    buffer_store_dwordx2 v[20:21], v18, s[12:15], s59 offen offset:96
    s_nop 1
    v_cvt_pk_bf16_f32 v20, v124, v125
    v_cvt_pk_bf16_f32 v21, v126, v127
    s_lshl_b32 s59, s50, 5
    buffer_store_dwordx2 v[20:21], v18, s[12:15], s59 offen offset:112
    s_nop 1
pjdone_1:
    s_endpgm
.globl chain_kernel
.p2align 8
.type chain_kernel,@function
chain_kernel:
    s_cmp_lt_u32 s2, 64
    s_cbranch_scc1 go_chain
    s_cmp_ge_u32 s2, 256
    s_cbranch_scc1 go_end
    s_sub_u32 s2, s2, 64
atop_14:
    s_cmp_ge_u32 s2, 256
    s_cbranch_scc1 adone_13
    s_load_dwordx16 s[16:31], s[0:1], 0
    s_load_dwordx16 s[32:47], s[0:1], 64
    s_and_b32 s60, s2, 15
    s_lshr_b32 s61, s2, 4
    s_sub_u32 s61, 15, s61
    v_and_b32 v1, 63, v0
    v_lshrrev_b32 v2, 6, v0
    v_and_b32 v3, 31, v1
    v_lshrrev_b32 v4, 5, v1
    s_waitcnt lgkmcnt(0)
    s_lshl_b32 s62, s61, 7
    v_lshl_add_u32 v5, v2, 5, v3
    v_add_u32 v5, s62, v5
    v_lshlrev_b32 v6, 13, v5
    v_lshl_add_u32 v6, v4, 4, v6
    s_lshl_b32 s63, s60, 9
    s_add_u32 s63, s63, 50331648
    v_add_u32 v6, s63, v6
    global_load_dwordx4 v[64:67], v6, s[46:47] offset:0
    global_load_dwordx4 v[68:71], v6, s[46:47] offset:32
    global_load_dwordx4 v[72:75], v6, s[46:47] offset:64
    global_load_dwordx4 v[76:79], v6, s[46:47] offset:96
    global_load_dwordx4 v[80:83], v6, s[46:47] offset:128
    global_load_dwordx4 v[84:87], v6, s[46:47] offset:160
    global_load_dwordx4 v[88:91], v6, s[46:47] offset:192
    global_load_dwordx4 v[92:95], v6, s[46:47] offset:224
    global_load_dwordx4 v[96:99], v6, s[46:47] offset:256
    global_load_dwordx4 v[100:103], v6, s[46:47] offset:288
    global_load_dwordx4 v[104:107], v6, s[46:47] offset:320
    global_load_dwordx4 v[108:111], v6, s[46:47] offset:352
    global_load_dwordx4 v[112:115], v6, s[46:47] offset:384
    global_load_dwordx4 v[116:119], v6, s[46:47] offset:416
    global_load_dwordx4 v[120:123], v6, s[46:47] offset:448
    global_load_dwordx4 v[124:127], v6, s[46:47] offset:480
    s_waitcnt vmcnt(0)
    v_accvgpr_write_b32 a0, v64
    v_accvgpr_write_b32 a1, v65
    v_accvgpr_write_b32 a2, v66
    v_accvgpr_write_b32 a3, v67
    v_accvgpr_write_b32 a4, v68
    v_accvgpr_write_b32 a5, v69
    v_accvgpr_write_b32 a6, v70
    v_accvgpr_write_b32 a7, v71
    v_accvgpr_write_b32 a8, v72
    v_accvgpr_write_b32 a9, v73
    v_accvgpr_write_b32 a10, v74
    v_accvgpr_write_b32 a11, v75
    v_accvgpr_write_b32 a12, v76
    v_accvgpr_write_b32 a13, v77
    v_accvgpr_write_b32 a14, v78
    v_accvgpr_write_b32 a15, v79
    v_accvgpr_write_b32 a16, v80
    v_accvgpr_write_b32 a17, v81
    v_accvgpr_write_b32 a18, v82
    v_accvgpr_write_b32 a19, v83
    v_accvgpr_write_b32 a20, v84
    v_accvgpr_write_b32 a21, v85
    v_accvgpr_write_b32 a22, v86
    v_accvgpr_write_b32 a23, v87
    v_accvgpr_write_b32 a24, v88
    v_accvgpr_write_b32 a25, v89
    v_accvgpr_write_b32 a26, v90
    v_accvgpr_write_b32 a27, v91
    v_accvgpr_write_b32 a28, v92
    v_accvgpr_write_b32 a29, v93
    v_accvgpr_write_b32 a30, v94
    v_accvgpr_write_b32 a31, v95
    v_accvgpr_write_b32 a32, v96
    v_accvgpr_write_b32 a33, v97
    v_accvgpr_write_b32 a34, v98
    v_accvgpr_write_b32 a35, v99
    v_accvgpr_write_b32 a36, v100
    v_accvgpr_write_b32 a37, v101
    v_accvgpr_write_b32 a38, v102
    v_accvgpr_write_b32 a39, v103
    v_accvgpr_write_b32 a40, v104
    v_accvgpr_write_b32 a41, v105
    v_accvgpr_write_b32 a42, v106
    v_accvgpr_write_b32 a43, v107
    v_accvgpr_write_b32 a44, v108
    v_accvgpr_write_b32 a45, v109
    v_accvgpr_write_b32 a46, v110
    v_accvgpr_write_b32 a47, v111
    v_accvgpr_write_b32 a48, v112
    v_accvgpr_write_b32 a49, v113
    v_accvgpr_write_b32 a50, v114
    v_accvgpr_write_b32 a51, v115
    v_accvgpr_write_b32 a52, v116
    v_accvgpr_write_b32 a53, v117
    v_accvgpr_write_b32 a54, v118
    v_accvgpr_write_b32 a55, v119
    v_accvgpr_write_b32 a56, v120
    v_accvgpr_write_b32 a57, v121
    v_accvgpr_write_b32 a58, v122
    v_accvgpr_write_b32 a59, v123
    v_accvgpr_write_b32 a60, v124
    v_accvgpr_write_b32 a61, v125
    v_accvgpr_write_b32 a62, v126
    v_accvgpr_write_b32 a63, v127
    v_mov_b32 v128, 0
    v_mov_b32 v129, 0
    v_mov_b32 v130, 0
    v_mov_b32 v131, 0
    v_mov_b32 v132, 0
    v_mov_b32 v133, 0
    v_mov_b32 v134, 0
    v_mov_b32 v135, 0
    v_mov_b32 v136, 0
    v_mov_b32 v137, 0
    v_mov_b32 v138, 0
    v_mov_b32 v139, 0
    v_mov_b32 v140, 0
    v_mov_b32 v141, 0
    v_mov_b32 v142, 0
    v_mov_b32 v143, 0
    v_mov_b32 v144, 0
    v_mov_b32 v145, 0
    v_mov_b32 v146, 0
    v_mov_b32 v147, 0
    v_mov_b32 v148, 0
    v_mov_b32 v149, 0
    v_mov_b32 v150, 0
    v_mov_b32 v151, 0
    v_mov_b32 v152, 0
    v_mov_b32 v153, 0
    v_mov_b32 v154, 0
    v_mov_b32 v155, 0
    v_mov_b32 v156, 0
    v_mov_b32 v157, 0
    v_mov_b32 v158, 0
    v_mov_b32 v159, 0
    v_mov_b32 v160, 0
    v_mov_b32 v161, 0
    v_mov_b32 v162, 0
    v_mov_b32 v163, 0
    v_mov_b32 v164, 0
    v_mov_b32 v165, 0
    v_mov_b32 v166, 0
    v_mov_b32 v167, 0
    v_mov_b32 v168, 0
    v_mov_b32 v169, 0
    v_mov_b32 v170, 0
    v_mov_b32 v171, 0
    v_mov_b32 v172, 0
    v_mov_b32 v173, 0
    v_mov_b32 v174, 0
    v_mov_b32 v175, 0
    v_mov_b32 v176, 0
    v_mov_b32 v177, 0
    v_mov_b32 v178, 0
    v_mov_b32 v179, 0
    v_mov_b32 v180, 0
    v_mov_b32 v181, 0
    v_mov_b32 v182, 0
    v_mov_b32 v183, 0
    v_mov_b32 v184, 0
    v_mov_b32 v185, 0
    v_mov_b32 v186, 0
    v_mov_b32 v187, 0
    v_mov_b32 v188, 0
    v_mov_b32 v189, 0
    v_mov_b32 v190, 0
    v_mov_b32 v191, 0
    v_mov_b32 v192, 0
    v_mov_b32 v193, 0
    v_mov_b32 v194, 0
    v_mov_b32 v195, 0
    v_mov_b32 v196, 0
    v_mov_b32 v197, 0
    v_mov_b32 v198, 0
    v_mov_b32 v199, 0
    v_mov_b32 v200, 0
    v_mov_b32 v201, 0
    v_mov_b32 v202, 0
    v_mov_b32 v203, 0
    v_mov_b32 v204, 0
    v_mov_b32 v205, 0
    v_mov_b32 v206, 0
    v_mov_b32 v207, 0
    v_mov_b32 v208, 0
    v_mov_b32 v209, 0
    v_mov_b32 v210, 0
    v_mov_b32 v211, 0
    v_mov_b32 v212, 0
    v_mov_b32 v213, 0
    v_mov_b32 v214, 0
    v_mov_b32 v215, 0
    v_mov_b32 v216, 0
    v_mov_b32 v217, 0
    v_mov_b32 v218, 0
    v_mov_b32 v219, 0
    v_mov_b32 v220, 0
    v_mov_b32 v221, 0
    v_mov_b32 v222, 0
    v_mov_b32 v223, 0
    v_mov_b32 v224, 0
    v_mov_b32 v225, 0
    v_mov_b32 v226, 0
    v_mov_b32 v227, 0
    v_mov_b32 v228, 0
    v_mov_b32 v229, 0
    v_mov_b32 v230, 0
    v_mov_b32 v231, 0
    v_mov_b32 v232, 0
    v_mov_b32 v233, 0
    v_mov_b32 v234, 0
    v_mov_b32 v235, 0
    v_mov_b32 v236, 0
    v_mov_b32 v237, 0
    v_mov_b32 v238, 0
    v_mov_b32 v239, 0
    v_mov_b32 v240, 0
    v_mov_b32 v241, 0
    v_mov_b32 v242, 0
    v_mov_b32 v243, 0
    v_mov_b32 v244, 0
    v_mov_b32 v245, 0
    v_mov_b32 v246, 0
    v_mov_b32 v247, 0
    v_mov_b32 v248, 0
    v_mov_b32 v249, 0
    v_mov_b32 v250, 0
    v_mov_b32 v251, 0
    v_mov_b32 v252, 0
    v_mov_b32 v253, 0
    v_mov_b32 v254, 0
    v_mov_b32 v255, 0
    v_mov_b32 v8, 0xf149f2ca
    v_mov_b32 v9, 0
    v_lshrrev_b32 v10, 5, v0
    v_and_b32 v11, 31, v0
    v_lshlrev_b32 v12, 14, v10
    v_lshl_add_u32 v12, v11, 4, v12
    s_lshl_b32 s63, s60, 9
    s_add_u32 s63, s63, 67108864
    v_add_u32 v12, s63, v12
    v_mul_u32_u24 v13, 528, v10
    v_lshl_add_u32 v13, v11, 4, v13
    v_mul_u32_u24 v14, 576, v10
    v_lshl_add_u32 v14, v11, 4, v14
    v_add_u32 v14, 33792, v14
    v_mul_u32_u24 v15, 528, v3
    v_lshl_add_u32 v15, v4, 4, v15
    v_and_b32 v16, 15, v1
    v_lshrrev_b32 v17, 2, v16
    v_lshl_add_u32 v17, v4, 2, v17
    v_mul_u32_u24 v17, 576, v17
    v_and_b32 v16, 3, v16
    v_lshl_add_u32 v17, v16, 3, v17
    v_bfe_u32 v16, v1, 4, 1
    v_lshl_add_u32 v17, v16, 5, v17
    v_add_u32 v17, 33792, v17
    s_add_u32 s64, s61, 1
    s_lshl_b32 s64, s64, 1
    s_mov_b32 s65, 0
    v_mov_b32 v19, 0x3e38aa3b
    v_mov_b32 v19, 0x3db8aa3b
aloop_15:
    global_load_dwordx4 v[64:67], v12, s[46:47] offset:0
    v_add_u32 v12, 131072, v12
    global_load_dwordx4 v[68:71], v12, s[46:47] offset:0
    v_add_u32 v12, 131072, v12
    global_load_dwordx4 v[72:75], v12, s[46:47] offset:0
    v_add_u32 v12, 131072, v12
    global_load_dwordx4 v[76:79], v12, s[46:47] offset:0
    v_add_u32 v12, 131072, v12
    global_load_dwordx4 v[80:83], v12, s[46:47] offset:0
    v_add_u32 v12, 131072, v12
    global_load_dwordx4 v[84:87], v12, s[46:47] offset:0
    v_add_u32 v12, 131072, v12
    global_load_dwordx4 v[88:91], v12, s[46:47] offset:0
    v_add_u32 v12, 131072, v12
    global_load_dwordx4 v[92:95], v12, s[46:47] offset:0
    v_add_u32 v12, 131072, v12
    v_subrev_u32 v12, 1040384, v12
    global_load_dwordx4 v[96:99], v12, s[46:47] offset:0
    v_add_u32 v12, 131072, v12
    global_load_dwordx4 v[100:103], v12, s[46:47] offset:0
    v_add_u32 v12, 131072, v12
    global_load_dwordx4 v[104:107], v12, s[46:47] offset:0
    v_add_u32 v12, 131072, v12
    global_load_dwordx4 v[108:111], v12, s[46:47] offset:0
    v_add_u32 v12, 131072, v12
    global_load_dwordx4 v[112:115], v12, s[46:47] offset:0
    v_add_u32 v12, 131072, v12
    global_load_dwordx4 v[116:119], v12, s[46:47] offset:0
    v_add_u32 v12, 131072, v12
    global_load_dwordx4 v[120:123], v12, s[46:47] offset:0
    v_add_u32 v12, 131072, v12
    global_load_dwordx4 v[124:127], v12, s[46:47] offset:0
    v_add_u32 v12, 131072, v12
    v_subrev_u32 v12, 8192, v12
    s_barrier
    s_waitcnt vmcnt(0)
    ds_write_b128 v13, v[64:67] offset:0
    ds_write_b128 v14, v[96:99] offset:0
    ds_write_b128 v13, v[68:71] offset:4224
    ds_write_b128 v14, v[100:103] offset:4608
    ds_write_b128 v13, v[72:75] offset:8448
    ds_write_b128 v14, v[104:107] offset:9216
    ds_write_b128 v13, v[76:79] offset:12672
    ds_write_b128 v14, v[108:111] offset:13824
    ds_write_b128 v13, v[80:83] offset:16896
    ds_write_b128 v14, v[112:115] offset:18432
    ds_write_b128 v13, v[84:87] offset:21120
    ds_write_b128 v14, v[116:119] offset:23040
    ds_write_b128 v13, v[88:91] offset:25344
    ds_write_b128 v14, v[120:123] offset:27648
    ds_write_b128 v13, v[92:95] offset:29568
    ds_write_b128 v14, v[124:127] offset:32256
    s_waitcnt lgkmcnt(0)
    s_barrier
    v_mov_b32 v32, 0
    v_mov_b32 v33, 0
    v_mov_b32 v34, 0
    v_mov_b32 v35, 0
    v_mov_b32 v36, 0
    v_mov_b32 v37, 0
    v_mov_b32 v38, 0
    v_mov_b32 v39, 0
    v_mov_b32 v40, 0
    v_mov_b32 v41, 0
    v_mov_b32 v42, 0
    v_mov_b32 v43, 0
    v_mov_b32 v44, 0
    v_mov_b32 v45, 0
    v_mov_b32 v46, 0
    v_mov_b32 v47, 0
    v_mov_b32 v48, 0
    v_mov_b32 v49, 0
    v_mov_b32 v50, 0
    v_mov_b32 v51, 0
    v_mov_b32 v52, 0
    v_mov_b32 v53, 0
    v_mov_b32 v54, 0
    v_mov_b32 v55, 0
    v_mov_b32 v56, 0
    v_mov_b32 v57, 0
    v_mov_b32 v58, 0
    v_mov_b32 v59, 0
    v_mov_b32 v60, 0
    v_mov_b32 v61, 0
    v_mov_b32 v62, 0
    v_mov_b32 v63, 0
    ds_read_b128 v[20:23], v15 offset:0
    ds_read_b128 v[24:27], v15 offset:16896
    s_waitcnt lgkmcnt(0)
    v_mfma_f32_32x32x16_bf16 v[32:47], v[20:23], a[0:3], v[32:47]
    v_mfma_f32_32x32x16_bf16 v[48:63], v[24:27], a[0:3], v[48:63]
    ds_read_b128 v[20:23], v15 offset:32
    ds_read_b128 v[24:27], v15 offset:16928
    s_waitcnt lgkmcnt(0)
    v_mfma_f32_32x32x16_bf16 v[32:47], v[20:23], a[4:7], v[32:47]
    v_mfma_f32_32x32x16_bf16 v[48:63], v[24:27], a[4:7], v[48:63]
    ds_read_b128 v[20:23], v15 offset:64
    ds_read_b128 v[24:27], v15 offset:16960
    s_waitcnt lgkmcnt(0)
    v_mfma_f32_32x32x16_bf16 v[32:47], v[20:23], a[8:11], v[32:47]
    v_mfma_f32_32x32x16_bf16 v[48:63], v[24:27], a[8:11], v[48:63]
    ds_read_b128 v[20:23], v15 offset:96
    ds_read_b128 v[24:27], v15 offset:16992
    s_waitcnt lgkmcnt(0)
    v_mfma_f32_32x32x16_bf16 v[32:47], v[20:23], a[12:15], v[32:47]
    v_mfma_f32_32x32x16_bf16 v[48:63], v[24:27], a[12:15], v[48:63]
    ds_read_b128 v[20:23], v15 offset:128
    ds_read_b128 v[24:27], v15 offset:17024
    s_waitcnt lgkmcnt(0)
    v_mfma_f32_32x32x16_bf16 v[32:47], v[20:23], a[16:19], v[32:47]
    v_mfma_f32_32x32x16_bf16 v[48:63], v[24:27], a[16:19], v[48:63]
    ds_read_b128 v[20:23], v15 offset:160
    ds_read_b128 v[24:27], v15 offset:17056
    s_waitcnt lgkmcnt(0)
    v_mfma_f32_32x32x16_bf16 v[32:47], v[20:23], a[20:23], v[32:47]
    v_mfma_f32_32x32x16_bf16 v[48:63], v[24:27], a[20:23], v[48:63]
    ds_read_b128 v[20:23], v15 offset:192
    ds_read_b128 v[24:27], v15 offset:17088
    s_waitcnt lgkmcnt(0)
    v_mfma_f32_32x32x16_bf16 v[32:47], v[20:23], a[24:27], v[32:47]
    v_mfma_f32_32x32x16_bf16 v[48:63], v[24:27], a[24:27], v[48:63]
    ds_read_b128 v[20:23], v15 offset:224
    ds_read_b128 v[24:27], v15 offset:17120
    s_waitcnt lgkmcnt(0)
    v_mfma_f32_32x32x16_bf16 v[32:47], v[20:23], a[28:31], v[32:47]
    v_mfma_f32_32x32x16_bf16 v[48:63], v[24:27], a[28:31], v[48:63]
    ds_read_b128 v[20:23], v15 offset:256
    ds_read_b128 v[24:27], v15 offset:17152
    s_waitcnt lgkmcnt(0)
    v_mfma_f32_32x32x16_bf16 v[32:47], v[20:23], a[32:35], v[32:47]
    v_mfma_f32_32x32x16_bf16 v[48:63], v[24:27], a[32:35], v[48:63]
    ds_read_b128 v[20:23], v15 offset:288
    ds_read_b128 v[24:27], v15 offset:17184
    s_waitcnt lgkmcnt(0)
    v_mfma_f32_32x32x16_bf16 v[32:47], v[20:23], a[36:39], v[32:47]
    v_mfma_f32_32x32x16_bf16 v[48:63], v[24:27], a[36:39], v[48:63]
    ds_read_b128 v[20:23], v15 offset:320
    ds_read_b128 v[24:27], v15 offset:17216
    s_waitcnt lgkmcnt(0)
    v_mfma_f32_32x32x16_bf16 v[32:47], v[20:23], a[40:43], v[32:47]
    v_mfma_f32_32x32x16_bf16 v[48:63], v[24:27], a[40:43], v[48:63]
    ds_read_b128 v[20:23], v15 offset:352
    ds_read_b128 v[24:27], v15 offset:17248
    s_waitcnt lgkmcnt(0)
    v_mfma_f32_32x32x16_bf16 v[32:47], v[20:23], a[44:47], v[32:47]
    v_mfma_f32_32x32x16_bf16 v[48:63], v[24:27], a[44:47], v[48:63]
    ds_read_b128 v[20:23], v15 offset:384
    ds_read_b128 v[24:27], v15 offset:17280
    s_waitcnt lgkmcnt(0)
    v_mfma_f32_32x32x16_bf16 v[32:47], v[20:23], a[48:51], v[32:47]
    v_mfma_f32_32x32x16_bf16 v[48:63], v[24:27], a[48:51], v[48:63]
    ds_read_b128 v[20:23], v15 offset:416
    ds_read_b128 v[24:27], v15 offset:17312
    s_waitcnt lgkmcnt(0)
    v_mfma_f32_32x32x16_bf16 v[32:47], v[20:23], a[52:55], v[32:47]
    v_mfma_f32_32x32x16_bf16 v[48:63], v[24:27], a[52:55], v[48:63]
    ds_read_b128 v[20:23], v15 offset:448
    ds_read_b128 v[24:27], v15 offset:17344
    s_waitcnt lgkmcnt(0)
    v_mfma_f32_32x32x16_bf16 v[32:47], v[20:23], a[56:59], v[32:47]
    v_mfma_f32_32x32x16_bf16 v[48:63], v[24:27], a[56:59], v[48:63]
    ds_read_b128 v[20:23], v15 offset:480
    ds_read_b128 v[24:27], v15 offset:17376
    s_waitcnt lgkmcnt(0)
    v_mfma_f32_32x32x16_bf16 v[32:47], v[20:23], a[60:63], v[32:47]
    v_mfma_f32_32x32x16_bf16 v[48:63], v[24:27], a[60:63], v[48:63]
    s_nop 15
    v_lshl_add_u32 v18, v4, 2, s65
    v_sub_u32 v18, v5, v18
    v_mov_b32 v28, 0xf149f2ca
    v_cmp_le_i32 vcc, 0, v18
    v_cndmask_b32 v32, v28, v32, vcc
    v_cmp_le_i32 vcc, 1, v18
    v_cndmask_b32 v33, v28, v33, vcc
    v_cmp_le_i32 vcc, 2, v18
    v_cndmask_b32 v34, v28, v34, vcc
    v_cmp_le_i32 vcc, 3, v18
    v_cndmask_b32 v35, v28, v35, vcc
    v_cmp_le_i32 vcc, 8, v18
    v_cndmask_b32 v36, v28, v36, vcc
    v_cmp_le_i32 vcc, 9, v18
    v_cndmask_b32 v37, v28, v37, vcc
    v_cmp_le_i32 vcc, 10, v18
    v_cndmask_b32 v38, v28, v38, vcc
    v_cmp_le_i32 vcc, 11, v18
    v_cndmask_b32 v39, v28, v39, vcc
    v_cmp_le_i32 vcc, 16, v18
    v_cndmask_b32 v40, v28, v40, vcc
    v_cmp_le_i32 vcc, 17, v18
    v_cndmask_b32 v41, v28, v41, vcc
    v_cmp_le_i32 vcc, 18, v18
    v_cndmask_b32 v42, v28, v42, vcc
    v_cmp_le_i32 vcc, 19, v18
    v_cndmask_b32 v43, v28, v43, vcc
    v_cmp_le_i32 vcc, 24, v18
    v_cndmask_b32 v44, v28, v44, vcc
    v_cmp_le_i32 vcc, 25, v18
    v_cndmask_b32 v45, v28, v45, vcc
    v_cmp_le_i32 vcc, 26, v18
    v_cndmask_b32 v46, v28, v46, vcc
    v_cmp_le_i32 vcc, 27, v18
    v_cndmask_b32 v47, v28, v47, vcc
    v_cmp_le_i32 vcc, 32, v18
    v_cndmask_b32 v48, v28, v48, vcc
    v_cmp_le_i32 vcc, 33, v18
    v_cndmask_b32 v49, v28, v49, vcc
    v_cmp_le_i32 vcc, 34, v18
    v_cndmask_b32 v50, v28, v50, vcc
    v_cmp_le_i32 vcc, 35, v18
    v_cndmask_b32 v51, v28, v51, vcc
    v_cmp_le_i32 vcc, 40, v18
    v_cndmask_b32 v52, v28, v52, vcc
    v_cmp_le_i32 vcc, 41, v18
    v_cndmask_b32 v53, v28, v53, vcc
    v_cmp_le_i32 vcc, 42, v18
    v_cndmask_b32 v54, v28, v54, vcc
    v_cmp_le_i32 vcc, 43, v18
    v_cndmask_b32 v55, v28, v55, vcc
    v_cmp_le_i32 vcc, 48, v18
    v_cndmask_b32 v56, v28, v56, vcc
    v_cmp_le_i32 vcc, 49, v18
    v_cndmask_b32 v57, v28, v57, vcc
    v_cmp_le_i32 vcc, 50, v18
    v_cndmask_b32 v58, v28, v58, vcc
    v_cmp_le_i32 vcc, 51, v18
    v_cndmask_b32 v59, v28, v59, vcc
    v_cmp_le_i32 vcc, 56, v18
    v_cndmask_b32 v60, v28, v60, vcc
    v_cmp_le_i32 vcc, 57, v18
    v_cndmask_b32 v61, v28, v61, vcc
    v_cmp_le_i32 vcc, 58, v18
    v_cndmask_b32 v62, v28, v62, vcc
    v_cmp_le_i32 vcc, 59, v18
    v_cndmask_b32 v63, v28, v63, vcc
    v_mov_b32 v20, v8
    v_max_f32 v20, v20, v32
    v_max_f32 v20, v20, v33
    v_max_f32 v20, v20, v34
    v_max_f32 v20, v20, v35
    v_max_f32 v20, v20, v36
    v_max_f32 v20, v20, v37
    v_max_f32 v20, v20, v38
    v_max_f32 v20, v20, v39
    v_max_f32 v20, v20, v40
    v_max_f32 v20, v20, v41
    v_max_f32 v20, v20, v42
    v_max_f32 v20, v20, v43
    v_max_f32 v20, v20, v44
    v_max_f32 v20, v20, v45
    v_max_f32 v20, v20, v46
    v_max_f32 v20, v20, v47
    v_max_f32 v20, v20, v48
    v_max_f32 v20, v20, v49
    v_max_f32 v20, v20, v50
    v_max_f32 v20, v20, v51
    v_max_f32 v20, v20, v52
    v_max_f32 v20, v20, v53
    v_max_f32 v20, v20, v54
    v_max_f32 v20, v20, v55
    v_max_f32 v20, v20, v56
    v_max_f32 v20, v20, v57
    v_max_f32 v20, v20, v58
    v_max_f32 v20, v20, v59
    v_max_f32 v20, v20, v60
    v_max_f32 v20, v20, v61
    v_max_f32 v20, v20, v62
    v_max_f32 v20, v20, v63
    v_mov_b32 v21, v20
    s_nop 1
    v_permlane32_swap_b32 v21, v20
    v_max_f32 v20, v20, v21
    v_sub_f32 v22, v8, v20
    v_mul_f32 v22, v19, v22
    v_exp_f32 v22, v22
    v_mov_b32 v8, v20
    v_mov_b32 v23, 0
    v_sub_f32 v32, v32, v20
    v_mul_f32 v32, v19, v32
    v_exp_f32 v32, v32
    v_sub_f32 v33, v33, v20
    v_mul_f32 v33, v19, v33
    v_exp_f32 v33, v33
    v_sub_f32 v34, v34, v20
    v_mul_f32 v34, v19, v34
    v_exp_f32 v34, v34
    v_sub_f32 v35, v35, v20
    v_mul_f32 v35, v19, v35
    v_exp_f32 v35, v35
    v_sub_f32 v36, v36, v20
    v_mul_f32 v36, v19, v36
    v_exp_f32 v36, v36
    v_sub_f32 v37, v37, v20
    v_mul_f32 v37, v19, v37
    v_exp_f32 v37, v37
    v_sub_f32 v38, v38, v20
    v_mul_f32 v38, v19, v38
    v_exp_f32 v38, v38
    v_sub_f32 v39, v39, v20
    v_mul_f32 v39, v19, v39
    v_exp_f32 v39, v39
    v_sub_f32 v40, v40, v20
    v_mul_f32 v40, v19, v40
    v_exp_f32 v40, v40
    v_sub_f32 v41, v41, v20
    v_mul_f32 v41, v19, v41
    v_exp_f32 v41, v41
    v_sub_f32 v42, v42, v20
    v_mul_f32 v42, v19, v42
    v_exp_f32 v42, v42
    v_sub_f32 v43, v43, v20
    v_mul_f32 v43, v19, v43
    v_exp_f32 v43, v43
    v_sub_f32 v44, v44, v20
    v_mul_f32 v44, v19, v44
    v_exp_f32 v44, v44
    v_sub_f32 v45, v45, v20
    v_mul_f32 v45, v19, v45
    v_exp_f32 v45, v45
    v_sub_f32 v46, v46, v20
    v_mul_f32 v46, v19, v46
    v_exp_f32 v46, v46
    v_sub_f32 v47, v47, v20
    v_mul_f32 v47, v19, v47
    v_exp_f32 v47, v47
    v_sub_f32 v48, v48, v20
    v_mul_f32 v48, v19, v48
    v_exp_f32 v48, v48
    v_sub_f32 v49, v49, v20
    v_mul_f32 v49, v19, v49
    v_exp_f32 v49, v49
    v_sub_f32 v50, v50, v20
    v_mul_f32 v50, v19, v50
    v_exp_f32 v50, v50
    v_sub_f32 v51, v51, v20
    v_mul_f32 v51, v19, v51
    v_exp_f32 v51, v51
    v_sub_f32 v52, v52, v20
    v_mul_f32 v52, v19, v52
    v_exp_f32 v52, v52
    v_sub_f32 v53, v53, v20
    v_mul_f32 v53, v19, v53
    v_exp_f32 v53, v53
    v_sub_f32 v54, v54, v20
    v_mul_f32 v54, v19, v54
    v_exp_f32 v54, v54
    v_sub_f32 v55, v55, v20
    v_mul_f32 v55, v19, v55
    v_exp_f32 v55, v55
    v_sub_f32 v56, v56, v20
    v_mul_f32 v56, v19, v56
    v_exp_f32 v56, v56
    v_sub_f32 v57, v57, v20
    v_mul_f32 v57, v19, v57
    v_exp_f32 v57, v57
    v_sub_f32 v58, v58, v20
    v_mul_f32 v58, v19, v58
    v_exp_f32 v58, v58
    v_sub_f32 v59, v59, v20
    v_mul_f32 v59, v19, v59
    v_exp_f32 v59, v59
    v_sub_f32 v60, v60, v20
    v_mul_f32 v60, v19, v60
    v_exp_f32 v60, v60
    v_sub_f32 v61, v61, v20
    v_mul_f32 v61, v19, v61
    v_exp_f32 v61, v61
    v_sub_f32 v62, v62, v20
    v_mul_f32 v62, v19, v62
    v_exp_f32 v62, v62
    v_sub_f32 v63, v63, v20
    v_mul_f32 v63, v19, v63
    v_exp_f32 v63, v63
    s_nop 0
    v_add_f32 v23, v23, v32
    v_add_f32 v23, v23, v33
    v_add_f32 v23, v23, v34
    v_add_f32 v23, v23, v35
    v_add_f32 v23, v23, v36
    v_add_f32 v23, v23, v37
    v_add_f32 v23, v23, v38
    v_add_f32 v23, v23, v39
    v_add_f32 v23, v23, v40
    v_add_f32 v23, v23, v41
    v_add_f32 v23, v23, v42
    v_add_f32 v23, v23, v43
    v_add_f32 v23, v23, v44
    v_add_f32 v23, v23, v45
    v_add_f32 v23, v23, v46
    v_add_f32 v23, v23, v47
    v_add_f32 v23, v23, v48
    v_add_f32 v23, v23, v49
    v_add_f32 v23, v23, v50
    v_add_f32 v23, v23, v51
    v_add_f32 v23, v23, v52
    v_add_f32 v23, v23, v53
    v_add_f32 v23, v23, v54
    v_add_f32 v23, v23, v55
    v_add_f32 v23, v23, v56
    v_add_f32 v23, v23, v57
    v_add_f32 v23, v23, v58
    v_add_f32 v23, v23, v59
    v_add_f32 v23, v23, v60
    v_add_f32 v23, v23, v61
    v_add_f32 v23, v23, v62
    v_add_f32 v23, v23, v63
    v_mul_f32 v9, v9, v22
    v_add_f32 v9, v9, v23
    v_mul_f32 v128, v22, v128
    v_mul_f32 v129, v22, v129
    v_mul_f32 v130, v22, v130
    v_mul_f32 v131, v22, v131
    v_mul_f32 v132, v22, v132
    v_mul_f32 v133, v22, v133
    v_mul_f32 v134, v22, v134
    v_mul_f32 v135, v22, v135
    v_mul_f32 v136, v22, v136
    v_mul_f32 v137, v22, v137
    v_mul_f32 v138, v22, v138
    v_mul_f32 v139, v22, v139
    v_mul_f32 v140, v22, v140
    v_mul_f32 v141, v22, v141
    v_mul_f32 v142, v22, v142
    v_mul_f32 v143, v22, v143
    v_mul_f32 v144, v22, v144
    v_mul_f32 v145, v22, v145
    v_mul_f32 v146, v22, v146
    v_mul_f32 v147, v22, v147
    v_mul_f32 v148, v22, v148
    v_mul_f32 v149, v22, v149
    v_mul_f32 v150, v22, v150
    v_mul_f32 v151, v22, v151
    v_mul_f32 v152, v22, v152
    v_mul_f32 v153, v22, v153
    v_mul_f32 v154, v22, v154
    v_mul_f32 v155, v22, v155
    v_mul_f32 v156, v22, v156
    v_mul_f32 v157, v22, v157
    v_mul_f32 v158, v22, v158
    v_mul_f32 v159, v22, v159
    v_mul_f32 v160, v22, v160
    v_mul_f32 v161, v22, v161
    v_mul_f32 v162, v22, v162
    v_mul_f32 v163, v22, v163
    v_mul_f32 v164, v22, v164
    v_mul_f32 v165, v22, v165
    v_mul_f32 v166, v22, v166
    v_mul_f32 v167, v22, v167
    v_mul_f32 v168, v22, v168
    v_mul_f32 v169, v22, v169
    v_mul_f32 v170, v22, v170
    v_mul_f32 v171, v22, v171
    v_mul_f32 v172, v22, v172
    v_mul_f32 v173, v22, v173
    v_mul_f32 v174, v22, v174
    v_mul_f32 v175, v22, v175
    v_mul_f32 v176, v22, v176
    v_mul_f32 v177, v22, v177
    v_mul_f32 v178, v22, v178
    v_mul_f32 v179, v22, v179
    v_mul_f32 v180, v22, v180
    v_mul_f32 v181, v22, v181
    v_mul_f32 v182, v22, v182
    v_mul_f32 v183, v22, v183
    v_mul_f32 v184, v22, v184
    v_mul_f32 v185, v22, v185
    v_mul_f32 v186, v22, v186
    v_mul_f32 v187, v22, v187
    v_mul_f32 v188, v22, v188
    v_mul_f32 v189, v22, v189
    v_mul_f32 v190, v22, v190
    v_mul_f32 v191, v22, v191
    v_mul_f32 v192, v22, v192
    v_mul_f32 v193, v22, v193
    v_mul_f32 v194, v22, v194
    v_mul_f32 v195, v22, v195
    v_mul_f32 v196, v22, v196
    v_mul_f32 v197, v22, v197
    v_mul_f32 v198, v22, v198
    v_mul_f32 v199, v22, v199
    v_mul_f32 v200, v22, v200
    v_mul_f32 v201, v22, v201
    v_mul_f32 v202, v22, v202
    v_mul_f32 v203, v22, v203
    v_mul_f32 v204, v22, v204
    v_mul_f32 v205, v22, v205
    v_mul_f32 v206, v22, v206
    v_mul_f32 v207, v22, v207
    v_mul_f32 v208, v22, v208
    v_mul_f32 v209, v22, v209
    v_mul_f32 v210, v22, v210
    v_mul_f32 v211, v22, v211
    v_mul_f32 v212, v22, v212
    v_mul_f32 v213, v22, v213
    v_mul_f32 v214, v22, v214
    v_mul_f32 v215, v22, v215
    v_mul_f32 v216, v22, v216
    v_mul_f32 v217, v22, v217
    v_mul_f32 v218, v22, v218
    v_mul_f32 v219, v22, v219
    v_mul_f32 v220, v22, v220
    v_mul_f32 v221, v22, v221
    v_mul_f32 v222, v22, v222
    v_mul_f32 v223, v22, v223
    v_mul_f32 v224, v22, v224
    v_mul_f32 v225, v22, v225
    v_mul_f32 v226, v22, v226
    v_mul_f32 v227, v22, v227
    v_mul_f32 v228, v22, v228
    v_mul_f32 v229, v22, v229
    v_mul_f32 v230, v22, v230
    v_mul_f32 v231, v22, v231
    v_mul_f32 v232, v22, v232
    v_mul_f32 v233, v22, v233
    v_mul_f32 v234, v22, v234
    v_mul_f32 v235, v22, v235
    v_mul_f32 v236, v22, v236
    v_mul_f32 v237, v22, v237
    v_mul_f32 v238, v22, v238
    v_mul_f32 v239, v22, v239
    v_mul_f32 v240, v22, v240
    v_mul_f32 v241, v22, v241
    v_mul_f32 v242, v22, v242
    v_mul_f32 v243, v22, v243
    v_mul_f32 v244, v22, v244
    v_mul_f32 v245, v22, v245
    v_mul_f32 v246, v22, v246
    v_mul_f32 v247, v22, v247
    v_mul_f32 v248, v22, v248
    v_mul_f32 v249, v22, v249
    v_mul_f32 v250, v22, v250
    v_mul_f32 v251, v22, v251
    v_mul_f32 v252, v22, v252
    v_mul_f32 v253, v22, v253
    v_mul_f32 v254, v22, v254
    v_mul_f32 v255, v22, v255
    v_cvt_pk_bf16_f32 v32, v32, v33
    v_cvt_pk_bf16_f32 v33, v34, v35
    v_cvt_pk_bf16_f32 v34, v36, v37
    v_cvt_pk_bf16_f32 v35, v38, v39
    v_cvt_pk_bf16_f32 v36, v40, v41
    v_cvt_pk_bf16_f32 v37, v42, v43
    v_cvt_pk_bf16_f32 v38, v44, v45
    v_cvt_pk_bf16_f32 v39, v46, v47
    v_cvt_pk_bf16_f32 v40, v48, v49
    v_cvt_pk_bf16_f32 v41, v50, v51
    v_cvt_pk_bf16_f32 v42, v52, v53
    v_cvt_pk_bf16_f32 v43, v54, v55
    v_cvt_pk_bf16_f32 v44, v56, v57
    v_cvt_pk_bf16_f32 v45, v58, v59
    v_cvt_pk_bf16_f32 v46, v60, v61
    v_cvt_pk_bf16_f32 v47, v62, v63
    s_nop 1
    ds_read_b64_tr_b16 v[24:25], v17 offset:0
    ds_read_b64_tr_b16 v[26:27], v17 offset:4608
    s_waitcnt lgkmcnt(0)
    v_mfma_f32_32x32x16_bf16 v[128:143], v[24:27], v[32:35], v[128:143]
    ds_read_b64_tr_b16 v[24:25], v17 offset:64
    ds_read_b64_tr_b16 v[26:27], v17 offset:4672
    s_waitcnt lgkmcnt(0)
    v_mfma_f32_32x32x16_bf16 v[144:159], v[24:27], v[32:35], v[144:159]
    ds_read_b64_tr_b16 v[24:25], v17 offset:128
    ds_read_b64_tr_b16 v[26:27], v17 offset:4736
    s_waitcnt lgkmcnt(0)
    v_mfma_f32_32x32x16_bf16 v[160:175], v[24:27], v[32:35], v[160:175]
    ds_read_b64_tr_b16 v[24:25], v17 offset:192
    ds_read_b64_tr_b16 v[26:27], v17 offset:4800
    s_waitcnt lgkmcnt(0)
    v_mfma_f32_32x32x16_bf16 v[176:191], v[24:27], v[32:35], v[176:191]
    ds_read_b64_tr_b16 v[24:25], v17 offset:256
    ds_read_b64_tr_b16 v[26:27], v17 offset:4864
    s_waitcnt lgkmcnt(0)
    v_mfma_f32_32x32x16_bf16 v[192:207], v[24:27], v[32:35], v[192:207]
    ds_read_b64_tr_b16 v[24:25], v17 offset:320
    ds_read_b64_tr_b16 v[26:27], v17 offset:4928
    s_waitcnt lgkmcnt(0)
    v_mfma_f32_32x32x16_bf16 v[208:223], v[24:27], v[32:35], v[208:223]
    ds_read_b64_tr_b16 v[24:25], v17 offset:384
    ds_read_b64_tr_b16 v[26:27], v17 offset:4992
    s_waitcnt lgkmcnt(0)
    v_mfma_f32_32x32x16_bf16 v[224:239], v[24:27], v[32:35], v[224:239]
    ds_read_b64_tr_b16 v[24:25], v17 offset:448
    ds_read_b64_tr_b16 v[26:27], v17 offset:5056
    s_waitcnt lgkmcnt(0)
    v_mfma_f32_32x32x16_bf16 v[240:255], v[24:27], v[32:35], v[240:255]
    ds_read_b64_tr_b16 v[24:25], v17 offset:9216
    ds_read_b64_tr_b16 v[26:27], v17 offset:13824
    s_waitcnt lgkmcnt(0)
    v_mfma_f32_32x32x16_bf16 v[128:143], v[24:27], v[36:39], v[128:143]
    ds_read_b64_tr_b16 v[24:25], v17 offset:9280
    ds_read_b64_tr_b16 v[26:27], v17 offset:13888
    s_waitcnt lgkmcnt(0)
    v_mfma_f32_32x32x16_bf16 v[144:159], v[24:27], v[36:39], v[144:159]
    ds_read_b64_tr_b16 v[24:25], v17 offset:9344
    ds_read_b64_tr_b16 v[26:27], v17 offset:13952
    s_waitcnt lgkmcnt(0)
    v_mfma_f32_32x32x16_bf16 v[160:175], v[24:27], v[36:39], v[160:175]
    ds_read_b64_tr_b16 v[24:25], v17 offset:9408
    ds_read_b64_tr_b16 v[26:27], v17 offset:14016
    s_waitcnt lgkmcnt(0)
    v_mfma_f32_32x32x16_bf16 v[176:191], v[24:27], v[36:39], v[176:191]
    ds_read_b64_tr_b16 v[24:25], v17 offset:9472
    ds_read_b64_tr_b16 v[26:27], v17 offset:14080
    s_waitcnt lgkmcnt(0)
    v_mfma_f32_32x32x16_bf16 v[192:207], v[24:27], v[36:39], v[192:207]
    ds_read_b64_tr_b16 v[24:25], v17 offset:9536
    ds_read_b64_tr_b16 v[26:27], v17 offset:14144
    s_waitcnt lgkmcnt(0)
    v_mfma_f32_32x32x16_bf16 v[208:223], v[24:27], v[36:39], v[208:223]
    ds_read_b64_tr_b16 v[24:25], v17 offset:9600
    ds_read_b64_tr_b16 v[26:27], v17 offset:14208
    s_waitcnt lgkmcnt(0)
    v_mfma_f32_32x32x16_bf16 v[224:239], v[24:27], v[36:39], v[224:239]
    ds_read_b64_tr_b16 v[24:25], v17 offset:9664
    ds_read_b64_tr_b16 v[26:27], v17 offset:14272
    s_waitcnt lgkmcnt(0)
    v_mfma_f32_32x32x16_bf16 v[240:255], v[24:27], v[36:39], v[240:255]
    ds_read_b64_tr_b16 v[24:25], v17 offset:18432
    ds_read_b64_tr_b16 v[26:27], v17 offset:23040
    s_waitcnt lgkmcnt(0)
    v_mfma_f32_32x32x16_bf16 v[128:143], v[24:27], v[40:43], v[128:143]
    ds_read_b64_tr_b16 v[24:25], v17 offset:18496
    ds_read_b64_tr_b16 v[26:27], v17 offset:23104
    s_waitcnt lgkmcnt(0)
    v_mfma_f32_32x32x16_bf16 v[144:159], v[24:27], v[40:43], v[144:159]
    ds_read_b64_tr_b16 v[24:25], v17 offset:18560
    ds_read_b64_tr_b16 v[26:27], v17 offset:23168
    s_waitcnt lgkmcnt(0)
    v_mfma_f32_32x32x16_bf16 v[160:175], v[24:27], v[40:43], v[160:175]
    ds_read_b64_tr_b16 v[24:25], v17 offset:18624
    ds_read_b64_tr_b16 v[26:27], v17 offset:23232
    s_waitcnt lgkmcnt(0)
    v_mfma_f32_32x32x16_bf16 v[176:191], v[24:27], v[40:43], v[176:191]
    ds_read_b64_tr_b16 v[24:25], v17 offset:18688
    ds_read_b64_tr_b16 v[26:27], v17 offset:23296
    s_waitcnt lgkmcnt(0)
    v_mfma_f32_32x32x16_bf16 v[192:207], v[24:27], v[40:43], v[192:207]
    ds_read_b64_tr_b16 v[24:25], v17 offset:18752
    ds_read_b64_tr_b16 v[26:27], v17 offset:23360
    s_waitcnt lgkmcnt(0)
    v_mfma_f32_32x32x16_bf16 v[208:223], v[24:27], v[40:43], v[208:223]
    ds_read_b64_tr_b16 v[24:25], v17 offset:18816
    ds_read_b64_tr_b16 v[26:27], v17 offset:23424
    s_waitcnt lgkmcnt(0)
    v_mfma_f32_32x32x16_bf16 v[224:239], v[24:27], v[40:43], v[224:239]
    ds_read_b64_tr_b16 v[24:25], v17 offset:18880
    ds_read_b64_tr_b16 v[26:27], v17 offset:23488
    s_waitcnt lgkmcnt(0)
    v_mfma_f32_32x32x16_bf16 v[240:255], v[24:27], v[40:43], v[240:255]
    ds_read_b64_tr_b16 v[24:25], v17 offset:27648
    ds_read_b64_tr_b16 v[26:27], v17 offset:32256
    s_waitcnt lgkmcnt(0)
    v_mfma_f32_32x32x16_bf16 v[128:143], v[24:27], v[44:47], v[128:143]
    ds_read_b64_tr_b16 v[24:25], v17 offset:27712
    ds_read_b64_tr_b16 v[26:27], v17 offset:32320
    s_waitcnt lgkmcnt(0)
    v_mfma_f32_32x32x16_bf16 v[144:159], v[24:27], v[44:47], v[144:159]
    ds_read_b64_tr_b16 v[24:25], v17 offset:27776
    ds_read_b64_tr_b16 v[26:27], v17 offset:32384
    s_waitcnt lgkmcnt(0)
    v_mfma_f32_32x32x16_bf16 v[160:175], v[24:27], v[44:47], v[160:175]
    ds_read_b64_tr_b16 v[24:25], v17 offset:27840
    ds_read_b64_tr_b16 v[26:27], v17 offset:32448
    s_waitcnt lgkmcnt(0)
    v_mfma_f32_32x32x16_bf16 v[176:191], v[24:27], v[44:47], v[176:191]
    ds_read_b64_tr_b16 v[24:25], v17 offset:27904
    ds_read_b64_tr_b16 v[26:27], v17 offset:32512
    s_waitcnt lgkmcnt(0)
    v_mfma_f32_32x32x16_bf16 v[192:207], v[24:27], v[44:47], v[192:207]
    ds_read_b64_tr_b16 v[24:25], v17 offset:27968
    ds_read_b64_tr_b16 v[26:27], v17 offset:32576
    s_waitcnt lgkmcnt(0)
    v_mfma_f32_32x32x16_bf16 v[208:223], v[24:27], v[44:47], v[208:223]
    ds_read_b64_tr_b16 v[24:25], v17 offset:28032
    ds_read_b64_tr_b16 v[26:27], v17 offset:32640
    s_waitcnt lgkmcnt(0)
    v_mfma_f32_32x32x16_bf16 v[224:239], v[24:27], v[44:47], v[224:239]
    ds_read_b64_tr_b16 v[24:25], v17 offset:28096
    ds_read_b64_tr_b16 v[26:27], v17 offset:32704
    s_waitcnt lgkmcnt(0)
    v_mfma_f32_32x32x16_bf16 v[240:255], v[24:27], v[44:47], v[240:255]
    s_add_u32 s65, s65, 64
    s_sub_u32 s64, s64, 1
    s_cmp_lg_u32 s64, 0
    s_cbranch_scc1 aloop_15
    s_nop 15
    v_mov_b32 v21, v9
    s_nop 1
    v_permlane32_swap_b32 v21, v9
    v_add_f32 v9, v9, v21
    v_rcp_f32 v9, v9
    v_lshlrev_b32 v6, 13, v5
    v_lshl_add_u32 v6, v4, 3, v6
    s_lshl_b32 s63, s60, 9
    s_add_u32 s63, s63, 100663296
    v_add_u32 v6, s63, v6
    v_mul_f32 v128, v9, v128
    v_mul_f32 v129, v9, v129
    v_mul_f32 v130, v9, v130
    v_mul_f32 v131, v9, v131
    v_cvt_pk_bf16_f32 v128, v128, v129
    v_cvt_pk_bf16_f32 v129, v130, v131
    global_store_dwordx2 v6, v[128:129], s[46:47] offset:0
    v_mul_f32 v132, v9, v132
    v_mul_f32 v133, v9, v133
    v_mul_f32 v134, v9, v134
    v_mul_f32 v135, v9, v135
    v_cvt_pk_bf16_f32 v132, v132, v133
    v_cvt_pk_bf16_f32 v133, v134, v135
    global_store_dwordx2 v6, v[132:133], s[46:47] offset:16
    v_mul_f32 v136, v9, v136
    v_mul_f32 v137, v9, v137
    v_mul_f32 v138, v9, v138
    v_mul_f32 v139, v9, v139
    v_cvt_pk_bf16_f32 v136, v136, v137
    v_cvt_pk_bf16_f32 v137, v138, v139
    global_store_dwordx2 v6, v[136:137], s[46:47] offset:32
    v_mul_f32 v140, v9, v140
    v_mul_f32 v141, v9, v141
    v_mul_f32 v142, v9, v142
    v_mul_f32 v143, v9, v143
    v_cvt_pk_bf16_f32 v140, v140, v141
    v_cvt_pk_bf16_f32 v141, v142, v143
    global_store_dwordx2 v6, v[140:141], s[46:47] offset:48
    v_mul_f32 v144, v9, v144
    v_mul_f32 v145, v9, v145
    v_mul_f32 v146, v9, v146
    v_mul_f32 v147, v9, v147
    v_cvt_pk_bf16_f32 v144, v144, v145
    v_cvt_pk_bf16_f32 v145, v146, v147
    global_store_dwordx2 v6, v[144:145], s[46:47] offset:64
    v_mul_f32 v148, v9, v148
    v_mul_f32 v149, v9, v149
    v_mul_f32 v150, v9, v150
    v_mul_f32 v151, v9, v151
    v_cvt_pk_bf16_f32 v148, v148, v149
    v_cvt_pk_bf16_f32 v149, v150, v151
    global_store_dwordx2 v6, v[148:149], s[46:47] offset:80
    v_mul_f32 v152, v9, v152
    v_mul_f32 v153, v9, v153
    v_mul_f32 v154, v9, v154
    v_mul_f32 v155, v9, v155
    v_cvt_pk_bf16_f32 v152, v152, v153
    v_cvt_pk_bf16_f32 v153, v154, v155
    global_store_dwordx2 v6, v[152:153], s[46:47] offset:96
    v_mul_f32 v156, v9, v156
    v_mul_f32 v157, v9, v157
    v_mul_f32 v158, v9, v158
    v_mul_f32 v159, v9, v159
    v_cvt_pk_bf16_f32 v156, v156, v157
    v_cvt_pk_bf16_f32 v157, v158, v159
    global_store_dwordx2 v6, v[156:157], s[46:47] offset:112
    v_mul_f32 v160, v9, v160
    v_mul_f32 v161, v9, v161
    v_mul_f32 v162, v9, v162
    v_mul_f32 v163, v9, v163
    v_cvt_pk_bf16_f32 v160, v160, v161
    v_cvt_pk_bf16_f32 v161, v162, v163
    global_store_dwordx2 v6, v[160:161], s[46:47] offset:128
    v_mul_f32 v164, v9, v164
    v_mul_f32 v165, v9, v165
    v_mul_f32 v166, v9, v166
    v_mul_f32 v167, v9, v167
    v_cvt_pk_bf16_f32 v164, v164, v165
    v_cvt_pk_bf16_f32 v165, v166, v167
    global_store_dwordx2 v6, v[164:165], s[46:47] offset:144
    v_mul_f32 v168, v9, v168
    v_mul_f32 v169, v9, v169
    v_mul_f32 v170, v9, v170
    v_mul_f32 v171, v9, v171
    v_cvt_pk_bf16_f32 v168, v168, v169
    v_cvt_pk_bf16_f32 v169, v170, v171
    global_store_dwordx2 v6, v[168:169], s[46:47] offset:160
    v_mul_f32 v172, v9, v172
    v_mul_f32 v173, v9, v173
    v_mul_f32 v174, v9, v174
    v_mul_f32 v175, v9, v175
    v_cvt_pk_bf16_f32 v172, v172, v173
    v_cvt_pk_bf16_f32 v173, v174, v175
    global_store_dwordx2 v6, v[172:173], s[46:47] offset:176
    v_mul_f32 v176, v9, v176
    v_mul_f32 v177, v9, v177
    v_mul_f32 v178, v9, v178
    v_mul_f32 v179, v9, v179
    v_cvt_pk_bf16_f32 v176, v176, v177
    v_cvt_pk_bf16_f32 v177, v178, v179
    global_store_dwordx2 v6, v[176:177], s[46:47] offset:192
    v_mul_f32 v180, v9, v180
    v_mul_f32 v181, v9, v181
    v_mul_f32 v182, v9, v182
    v_mul_f32 v183, v9, v183
    v_cvt_pk_bf16_f32 v180, v180, v181
    v_cvt_pk_bf16_f32 v181, v182, v183
    global_store_dwordx2 v6, v[180:181], s[46:47] offset:208
    v_mul_f32 v184, v9, v184
    v_mul_f32 v185, v9, v185
    v_mul_f32 v186, v9, v186
    v_mul_f32 v187, v9, v187
    v_cvt_pk_bf16_f32 v184, v184, v185
    v_cvt_pk_bf16_f32 v185, v186, v187
    global_store_dwordx2 v6, v[184:185], s[46:47] offset:224
    v_mul_f32 v188, v9, v188
    v_mul_f32 v189, v9, v189
    v_mul_f32 v190, v9, v190
    v_mul_f32 v191, v9, v191
    v_cvt_pk_bf16_f32 v188, v188, v189
    v_cvt_pk_bf16_f32 v189, v190, v191
    global_store_dwordx2 v6, v[188:189], s[46:47] offset:240
    v_mul_f32 v192, v9, v192
    v_mul_f32 v193, v9, v193
    v_mul_f32 v194, v9, v194
    v_mul_f32 v195, v9, v195
    v_cvt_pk_bf16_f32 v192, v192, v193
    v_cvt_pk_bf16_f32 v193, v194, v195
    global_store_dwordx2 v6, v[192:193], s[46:47] offset:256
    v_mul_f32 v196, v9, v196
    v_mul_f32 v197, v9, v197
    v_mul_f32 v198, v9, v198
    v_mul_f32 v199, v9, v199
    v_cvt_pk_bf16_f32 v196, v196, v197
    v_cvt_pk_bf16_f32 v197, v198, v199
    global_store_dwordx2 v6, v[196:197], s[46:47] offset:272
    v_mul_f32 v200, v9, v200
    v_mul_f32 v201, v9, v201
    v_mul_f32 v202, v9, v202
    v_mul_f32 v203, v9, v203
    v_cvt_pk_bf16_f32 v200, v200, v201
    v_cvt_pk_bf16_f32 v201, v202, v203
    global_store_dwordx2 v6, v[200:201], s[46:47] offset:288
    v_mul_f32 v204, v9, v204
    v_mul_f32 v205, v9, v205
    v_mul_f32 v206, v9, v206
    v_mul_f32 v207, v9, v207
    v_cvt_pk_bf16_f32 v204, v204, v205
    v_cvt_pk_bf16_f32 v205, v206, v207
    global_store_dwordx2 v6, v[204:205], s[46:47] offset:304
    v_mul_f32 v208, v9, v208
    v_mul_f32 v209, v9, v209
    v_mul_f32 v210, v9, v210
    v_mul_f32 v211, v9, v211
    v_cvt_pk_bf16_f32 v208, v208, v209
    v_cvt_pk_bf16_f32 v209, v210, v211
    global_store_dwordx2 v6, v[208:209], s[46:47] offset:320
    v_mul_f32 v212, v9, v212
    v_mul_f32 v213, v9, v213
    v_mul_f32 v214, v9, v214
    v_mul_f32 v215, v9, v215
    v_cvt_pk_bf16_f32 v212, v212, v213
    v_cvt_pk_bf16_f32 v213, v214, v215
    global_store_dwordx2 v6, v[212:213], s[46:47] offset:336
    v_mul_f32 v216, v9, v216
    v_mul_f32 v217, v9, v217
    v_mul_f32 v218, v9, v218
    v_mul_f32 v219, v9, v219
    v_cvt_pk_bf16_f32 v216, v216, v217
    v_cvt_pk_bf16_f32 v217, v218, v219
    global_store_dwordx2 v6, v[216:217], s[46:47] offset:352
    v_mul_f32 v220, v9, v220
    v_mul_f32 v221, v9, v221
    v_mul_f32 v222, v9, v222
    v_mul_f32 v223, v9, v223
    v_cvt_pk_bf16_f32 v220, v220, v221
    v_cvt_pk_bf16_f32 v221, v222, v223
    global_store_dwordx2 v6, v[220:221], s[46:47] offset:368
    v_mul_f32 v224, v9, v224
    v_mul_f32 v225, v9, v225
    v_mul_f32 v226, v9, v226
    v_mul_f32 v227, v9, v227
    v_cvt_pk_bf16_f32 v224, v224, v225
    v_cvt_pk_bf16_f32 v225, v226, v227
    global_store_dwordx2 v6, v[224:225], s[46:47] offset:384
    v_mul_f32 v228, v9, v228
    v_mul_f32 v229, v9, v229
    v_mul_f32 v230, v9, v230
    v_mul_f32 v231, v9, v231
    v_cvt_pk_bf16_f32 v228, v228, v229
    v_cvt_pk_bf16_f32 v229, v230, v231
    global_store_dwordx2 v6, v[228:229], s[46:47] offset:400
    v_mul_f32 v232, v9, v232
    v_mul_f32 v233, v9, v233
    v_mul_f32 v234, v9, v234
    v_mul_f32 v235, v9, v235
    v_cvt_pk_bf16_f32 v232, v232, v233
    v_cvt_pk_bf16_f32 v233, v234, v235
    global_store_dwordx2 v6, v[232:233], s[46:47] offset:416
    v_mul_f32 v236, v9, v236
    v_mul_f32 v237, v9, v237
    v_mul_f32 v238, v9, v238
    v_mul_f32 v239, v9, v239
    v_cvt_pk_bf16_f32 v236, v236, v237
    v_cvt_pk_bf16_f32 v237, v238, v239
    global_store_dwordx2 v6, v[236:237], s[46:47] offset:432
    v_mul_f32 v240, v9, v240
    v_mul_f32 v241, v9, v241
    v_mul_f32 v242, v9, v242
    v_mul_f32 v243, v9, v243
    v_cvt_pk_bf16_f32 v240, v240, v241
    v_cvt_pk_bf16_f32 v241, v242, v243
    global_store_dwordx2 v6, v[240:241], s[46:47] offset:448
    v_mul_f32 v244, v9, v244
    v_mul_f32 v245, v9, v245
    v_mul_f32 v246, v9, v246
    v_mul_f32 v247, v9, v247
    v_cvt_pk_bf16_f32 v244, v244, v245
    v_cvt_pk_bf16_f32 v245, v246, v247
    global_store_dwordx2 v6, v[244:245], s[46:47] offset:464
    v_mul_f32 v248, v9, v248
    v_mul_f32 v249, v9, v249
    v_mul_f32 v250, v9, v250
    v_mul_f32 v251, v9, v251
    v_cvt_pk_bf16_f32 v248, v248, v249
    v_cvt_pk_bf16_f32 v249, v250, v251
    global_store_dwordx2 v6, v[248:249], s[46:47] offset:480
    v_mul_f32 v252, v9, v252
    v_mul_f32 v253, v9, v253
    v_mul_f32 v254, v9, v254
    v_mul_f32 v255, v9, v255
    v_cvt_pk_bf16_f32 v252, v252, v253
    v_cvt_pk_bf16_f32 v253, v254, v255
    global_store_dwordx2 v6, v[252:253], s[46:47] offset:496
    s_add_u32 s2, s2, 192
    s_barrier
    s_branch atop_14
adone_13:
    s_endpgm
go_end:
    s_endpgm
go_chain:
    s_cmp_ge_u32 s2, 64
    s_cbranch_scc1 cdone_16
    s_load_dwordx16 s[16:31], s[0:1], 0
    s_load_dwordx16 s[32:47], s[0:1], 64
    v_and_b32 v1, 63, v0
    v_lshrrev_b32 v2, 6, v0
    s_nop 0
    v_readfirstlane_b32 s60, v2
    s_waitcnt lgkmcnt(0)
    v_lshrrev_b32 v3, 1, v1
    v_and_b32 v4, 1, v1
    v_lshlrev_b32 v5, 13, v3
    v_lshl_add_u32 v5, v4, 4, v5
    v_mul_u32_u24 v6, 14336, v2
    v_lshl_add_u32 v7, v3, 5, v6
    v_lshl_add_u32 v7, v4, 4, v7
    v_and_b32 v8, 15, v1
    v_lshrrev_b32 v9, 4, v1
    v_lshrrev_b32 v10, 2, v8
    v_lshl_add_u32 v10, v9, 3, v10
    v_lshlrev_b32 v10, 5, v10
    v_and_b32 v8, 3, v8
    v_lshl_add_u32 v10, v8, 3, v10
    v_add_u32 v10, v10, v6
    s_mul_i32 s61, s2, 12
    s_mul_i32 s62, s60, 3
    s_add_u32 s61, s61, s62
    s_add_u32 s61, s61, 0
    s_lshr_b32 s62, s61, 8
    s_and_b32 s61, s61, 255
    s_lshl_b32 s61, s61, 5
    s_lshl_b32 s62, s62, 1
    s_add_u32 s62, s62, 20
    s_cmp_eq_u32 s62, 20
    s_cselect_b32 s64, s20, s22
    s_cselect_b32 s65, s21, s23
    s_cmp_eq_u32 s62, 24
    s_cselect_b32 s64, s24, s64
    s_cselect_b32 s65, s25, s65
    s_add_u32 s64, s64, s61
    s_addc_u32 s65, s65, 0
    global_load_dwordx4 v[16:19], v5, s[64:65] offset:0
    v_add_u32 v5, 0x40000, v5
    global_load_dwordx4 v[20:23], v5, s[64:65] offset:0
    v_add_u32 v5, 0x40000, v5
    global_load_dwordx4 v[24:27], v5, s[64:65] offset:0
    v_add_u32 v5, 0x40000, v5
    global_load_dwordx4 v[28:31], v5, s[64:65] offset:0
    v_add_u32 v5, 0x40000, v5
    global_load_dwordx4 v[32:35], v5, s[64:65] offset:0
    v_add_u32 v5, 0x40000, v5
    global_load_dwordx4 v[36:39], v5, s[64:65] offset:0
    v_add_u32 v5, 0x40000, v5
    global_load_dwordx4 v[40:43], v5, s[64:65] offset:0
    v_add_u32 v5, 0x40000, v5
    global_load_dwordx4 v[44:47], v5, s[64:65] offset:0
    v_add_u32 v5, 0x40000, v5
    global_load_dwordx4 v[48:51], v5, s[64:65] offset:0
    v_add_u32 v5, 0x40000, v5
    global_load_dwordx4 v[52:55], v5, s[64:65] offset:0
    v_add_u32 v5, 0x40000, v5
    global_load_dwordx4 v[56:59], v5, s[64:65] offset:0
    v_add_u32 v5, 0x40000, v5
    global_load_dwordx4 v[60:63], v5, s[64:65] offset:0
    v_add_u32 v5, 0x40000, v5
    global_load_dwordx4 v[64:67], v5, s[64:65] offset:0
    v_add_u32 v5, 0x40000, v5
    global_load_dwordx4 v[68:71], v5, s[64:65] offset:0
    v_add_u32 v5, 0x40000, v5
    v_subrev_u32 v5, 0x380000, v5
    s_waitcnt vmcnt(0)
    ds_write_b128 v7, v[16:19] offset:0
    ds_write_b128 v7, v[20:23] offset:1024
    ds_write_b128 v7, v[24:27] offset:2048
    ds_write_b128 v7, v[28:31] offset:3072
    ds_write_b128 v7, v[32:35] offset:4096
    ds_write_b128 v7, v[36:39] offset:5120
    ds_write_b128 v7, v[40:43] offset:6144
    ds_write_b128 v7, v[44:47] offset:7168
    ds_write_b128 v7, v[48:51] offset:8192
    ds_write_b128 v7, v[52:55] offset:9216
    ds_write_b128 v7, v[56:59] offset:10240
    ds_write_b128 v7, v[60:63] offset:11264
    ds_write_b128 v7, v[64:67] offset:12288
    ds_write_b128 v7, v[68:71] offset:13312
    s_waitcnt lgkmcnt(0)
    ds_read_b64_tr_b16 v[80:81], v10 offset:0
    ds_read_b64_tr_b16 v[82:83], v10 offset:128
    s_waitcnt lgkmcnt(0)
    v_accvgpr_write_b32 a0, v80
    v_accvgpr_write_b32 a1, v81
    v_accvgpr_write_b32 a2, v82
    v_accvgpr_write_b32 a3, v83
    ds_read_b64_tr_b16 v[80:81], v10 offset:1024
    ds_read_b64_tr_b16 v[82:83], v10 offset:1152
    s_waitcnt lgkmcnt(0)
    v_accvgpr_write_b32 a4, v80
    v_accvgpr_write_b32 a5, v81
    v_accvgpr_write_b32 a6, v82
    v_accvgpr_write_b32 a7, v83
    ds_read_b64_tr_b16 v[80:81], v10 offset:2048
    ds_read_b64_tr_b16 v[82:83], v10 offset:2176
    s_waitcnt lgkmcnt(0)
    v_accvgpr_write_b32 a8, v80
    v_accvgpr_write_b32 a9, v81
    v_accvgpr_write_b32 a10, v82
    v_accvgpr_write_b32 a11, v83
    ds_read_b64_tr_b16 v[80:81], v10 offset:3072
    ds_read_b64_tr_b16 v[82:83], v10 offset:3200
    s_waitcnt lgkmcnt(0)
    v_accvgpr_write_b32 a12, v80
    v_accvgpr_write_b32 a13, v81
    v_accvgpr_write_b32 a14, v82
    v_accvgpr_write_b32 a15, v83
    ds_read_b64_tr_b16 v[80:81], v10 offset:4096
    ds_read_b64_tr_b16 v[82:83], v10 offset:4224
    s_waitcnt lgkmcnt(0)
    v_accvgpr_write_b32 a16, v80
    v_accvgpr_write_b32 a17, v81
    v_accvgpr_write_b32 a18, v82
    v_accvgpr_write_b32 a19, v83
    ds_read_b64_tr_b16 v[80:81], v10 offset:5120
    ds_read_b64_tr_b16 v[82:83], v10 offset:5248
    s_waitcnt lgkmcnt(0)
    v_accvgpr_write_b32 a20, v80
    v_accvgpr_write_b32 a21, v81
    v_accvgpr_write_b32 a22, v82
    v_accvgpr_write_b32 a23, v83
    ds_read_b64_tr_b16 v[80:81], v10 offset:6144
    ds_read_b64_tr_b16 v[82:83], v10 offset:6272
    s_waitcnt lgkmcnt(0)
    v_accvgpr_write_b32 a24, v80
    v_accvgpr_write_b32 a25, v81
    v_accvgpr_write_b32 a26, v82
    v_accvgpr_write_b32 a27, v83
    ds_read_b64_tr_b16 v[80:81], v10 offset:7168
    ds_read_b64_tr_b16 v[82:83], v10 offset:7296
    s_waitcnt lgkmcnt(0)
    v_accvgpr_write_b32 a28, v80
    v_accvgpr_write_b32 a29, v81
    v_accvgpr_write_b32 a30, v82
    v_accvgpr_write_b32 a31, v83
    ds_read_b64_tr_b16 v[80:81], v10 offset:8192
    ds_read_b64_tr_b16 v[82:83], v10 offset:8320
    s_waitcnt lgkmcnt(0)
    v_accvgpr_write_b32 a32, v80
    v_accvgpr_write_b32 a33, v81
    v_accvgpr_write_b32 a34, v82
    v_accvgpr_write_b32 a35, v83
    ds_read_b64_tr_b16 v[80:81], v10 offset:9216
    ds_read_b64_tr_b16 v[82:83], v10 offset:9344
    s_waitcnt lgkmcnt(0)
    v_accvgpr_write_b32 a36, v80
    v_accvgpr_write_b32 a37, v81
    v_accvgpr_write_b32 a38, v82
    v_accvgpr_write_b32 a39, v83
    ds_read_b64_tr_b16 v[80:81], v10 offset:10240
    ds_read_b64_tr_b16 v[82:83], v10 offset:10368
    s_waitcnt lgkmcnt(0)
    v_accvgpr_write_b32 a40, v80
    v_accvgpr_write_b32 a41, v81
    v_accvgpr_write_b32 a42, v82
    v_accvgpr_write_b32 a43, v83
    ds_read_b64_tr_b16 v[80:81], v10 offset:11264
    ds_read_b64_tr_b16 v[82:83], v10 offset:11392
    s_waitcnt lgkmcnt(0)
    v_accvgpr_write_b32 a44, v80
    v_accvgpr_write_b32 a45, v81
    v_accvgpr_write_b32 a46, v82
    v_accvgpr_write_b32 a47, v83
    ds_read_b64_tr_b16 v[80:81], v10 offset:12288
    ds_read_b64_tr_b16 v[82:83], v10 offset:12416
    s_waitcnt lgkmcnt(0)
    v_accvgpr_write_b32 a48, v80
    v_accvgpr_write_b32 a49, v81
    v_accvgpr_write_b32 a50, v82
    v_accvgpr_write_b32 a51, v83
    ds_read_b64_tr_b16 v[80:81], v10 offset:13312
    ds_read_b64_tr_b16 v[82:83], v10 offset:13440
    s_waitcnt lgkmcnt(0)
    v_accvgpr_write_b32 a52, v80
    v_accvgpr_write_b32 a53, v81
    v_accvgpr_write_b32 a54, v82
    v_accvgpr_write_b32 a55, v83
    s_mul_i32 s61, s2, 12
    s_mul_i32 s62, s60, 3
    s_add_u32 s61, s61, s62
    s_add_u32 s61, s61, 1
    s_lshr_b32 s62, s61, 8
    s_and_b32 s61, s61, 255
    s_lshl_b32 s61, s61, 5
    s_lshl_b32 s62, s62, 1
    s_add_u32 s62, s62, 20
    s_cmp_eq_u32 s62, 20
    s_cselect_b32 s64, s20, s22
    s_cselect_b32 s65, s21, s23
    s_cmp_eq_u32 s62, 24
    s_cselect_b32 s64, s24, s64
    s_cselect_b32 s65, s25, s65
    s_add_u32 s64, s64, s61
    s_addc_u32 s65, s65, 0
    global_load_dwordx4 v[16:19], v5, s[64:65] offset:0
    v_add_u32 v5, 0x40000, v5
    global_load_dwordx4 v[20:23], v5, s[64:65] offset:0
    v_add_u32 v5, 0x40000, v5
    global_load_dwordx4 v[24:27], v5, s[64:65] offset:0
    v_add_u32 v5, 0x40000, v5
    global_load_dwordx4 v[28:31], v5, s[64:65] offset:0
    v_add_u32 v5, 0x40000, v5
    global_load_dwordx4 v[32:35], v5, s[64:65] offset:0
    v_add_u32 v5, 0x40000, v5
    global_load_dwordx4 v[36:39], v5, s[64:65] offset:0
    v_add_u32 v5, 0x40000, v5
    global_load_dwordx4 v[40:43], v5, s[64:65] offset:0
    v_add_u32 v5, 0x40000, v5
    global_load_dwordx4 v[44:47], v5, s[64:65] offset:0
    v_add_u32 v5, 0x40000, v5
    global_load_dwordx4 v[48:51], v5, s[64:65] offset:0
    v_add_u32 v5, 0x40000, v5
    global_load_dwordx4 v[52:55], v5, s[64:65] offset:0
    v_add_u32 v5, 0x40000, v5
    global_load_dwordx4 v[56:59], v5, s[64:65] offset:0
    v_add_u32 v5, 0x40000, v5
    global_load_dwordx4 v[60:63], v5, s[64:65] offset:0
    v_add_u32 v5, 0x40000, v5
    global_load_dwordx4 v[64:67], v5, s[64:65] offset:0
    v_add_u32 v5, 0x40000, v5
    global_load_dwordx4 v[68:71], v5, s[64:65] offset:0
    v_add_u32 v5, 0x40000, v5
    v_subrev_u32 v5, 0x380000, v5
    s_waitcnt vmcnt(0)
    ds_write_b128 v7, v[16:19] offset:0
    ds_write_b128 v7, v[20:23] offset:1024
    ds_write_b128 v7, v[24:27] offset:2048
    ds_write_b128 v7, v[28:31] offset:3072
    ds_write_b128 v7, v[32:35] offset:4096
    ds_write_b128 v7, v[36:39] offset:5120
    ds_write_b128 v7, v[40:43] offset:6144
    ds_write_b128 v7, v[44:47] offset:7168
    ds_write_b128 v7, v[48:51] offset:8192
    ds_write_b128 v7, v[52:55] offset:9216
    ds_write_b128 v7, v[56:59] offset:10240
    ds_write_b128 v7, v[60:63] offset:11264
    ds_write_b128 v7, v[64:67] offset:12288
    ds_write_b128 v7, v[68:71] offset:13312
    s_waitcnt lgkmcnt(0)
    ds_read_b64_tr_b16 v[80:81], v10 offset:0
    ds_read_b64_tr_b16 v[82:83], v10 offset:128
    s_waitcnt lgkmcnt(0)
    v_accvgpr_write_b32 a56, v80
    v_accvgpr_write_b32 a57, v81
    v_accvgpr_write_b32 a58, v82
    v_accvgpr_write_b32 a59, v83
    ds_read_b64_tr_b16 v[80:81], v10 offset:1024
    ds_read_b64_tr_b16 v[82:83], v10 offset:1152
    s_waitcnt lgkmcnt(0)
    v_accvgpr_write_b32 a60, v80
    v_accvgpr_write_b32 a61, v81
    v_accvgpr_write_b32 a62, v82
    v_accvgpr_write_b32 a63, v83
    ds_read_b64_tr_b16 v[80:81], v10 offset:2048
    ds_read_b64_tr_b16 v[82:83], v10 offset:2176
    s_waitcnt lgkmcnt(0)
    v_accvgpr_write_b32 a64, v80
    v_accvgpr_write_b32 a65, v81
    v_accvgpr_write_b32 a66, v82
    v_accvgpr_write_b32 a67, v83
    ds_read_b64_tr_b16 v[80:81], v10 offset:3072
    ds_read_b64_tr_b16 v[82:83], v10 offset:3200
    s_waitcnt lgkmcnt(0)
    v_accvgpr_write_b32 a68, v80
    v_accvgpr_write_b32 a69, v81
    v_accvgpr_write_b32 a70, v82
    v_accvgpr_write_b32 a71, v83
    ds_read_b64_tr_b16 v[80:81], v10 offset:4096
    ds_read_b64_tr_b16 v[82:83], v10 offset:4224
    s_waitcnt lgkmcnt(0)
    v_accvgpr_write_b32 a72, v80
    v_accvgpr_write_b32 a73, v81
    v_accvgpr_write_b32 a74, v82
    v_accvgpr_write_b32 a75, v83
    ds_read_b64_tr_b16 v[80:81], v10 offset:5120
    ds_read_b64_tr_b16 v[82:83], v10 offset:5248
    s_waitcnt lgkmcnt(0)
    v_accvgpr_write_b32 a76, v80
    v_accvgpr_write_b32 a77, v81
    v_accvgpr_write_b32 a78, v82
    v_accvgpr_write_b32 a79, v83
    ds_read_b64_tr_b16 v[80:81], v10 offset:6144
    ds_read_b64_tr_b16 v[82:83], v10 offset:6272
    s_waitcnt lgkmcnt(0)
    v_accvgpr_write_b32 a80, v80
    v_accvgpr_write_b32 a81, v81
    v_accvgpr_write_b32 a82, v82
    v_accvgpr_write_b32 a83, v83
    ds_read_b64_tr_b16 v[80:81], v10 offset:7168
    ds_read_b64_tr_b16 v[82:83], v10 offset:7296
    s_waitcnt lgkmcnt(0)
    v_accvgpr_write_b32 a84, v80
    v_accvgpr_write_b32 a85, v81
    v_accvgpr_write_b32 a86, v82
    v_accvgpr_write_b32 a87, v83
    ds_read_b64_tr_b16 v[80:81], v10 offset:8192
    ds_read_b64_tr_b16 v[82:83], v10 offset:8320
    s_waitcnt lgkmcnt(0)
    v_accvgpr_write_b32 a88, v80
    v_accvgpr_write_b32 a89, v81
    v_accvgpr_write_b32 a90, v82
    v_accvgpr_write_b32 a91, v83
    ds_read_b64_tr_b16 v[80:81], v10 offset:9216
    ds_read_b64_tr_b16 v[82:83], v10 offset:9344
    s_waitcnt lgkmcnt(0)
    v_accvgpr_write_b32 a92, v80
    v_accvgpr_write_b32 a93, v81
    v_accvgpr_write_b32 a94, v82
    v_accvgpr_write_b32 a95, v83
    ds_read_b64_tr_b16 v[80:81], v10 offset:10240
    ds_read_b64_tr_b16 v[82:83], v10 offset:10368
    s_waitcnt lgkmcnt(0)
    v_accvgpr_write_b32 a96, v80
    v_accvgpr_write_b32 a97, v81
    v_accvgpr_write_b32 a98, v82
    v_accvgpr_write_b32 a99, v83
    ds_read_b64_tr_b16 v[80:81], v10 offset:11264
    ds_read_b64_tr_b16 v[82:83], v10 offset:11392
    s_waitcnt lgkmcnt(0)
    v_accvgpr_write_b32 a100, v80
    v_accvgpr_write_b32 a101, v81
    v_accvgpr_write_b32 a102, v82
    v_accvgpr_write_b32 a103, v83
    ds_read_b64_tr_b16 v[80:81], v10 offset:12288
    ds_read_b64_tr_b16 v[82:83], v10 offset:12416
    s_waitcnt lgkmcnt(0)
    v_accvgpr_write_b32 a104, v80
    v_accvgpr_write_b32 a105, v81
    v_accvgpr_write_b32 a106, v82
    v_accvgpr_write_b32 a107, v83
    ds_read_b64_tr_b16 v[80:81], v10 offset:13312
    ds_read_b64_tr_b16 v[82:83], v10 offset:13440
    s_waitcnt lgkmcnt(0)
    v_accvgpr_write_b32 a108, v80
    v_accvgpr_write_b32 a109, v81
    v_accvgpr_write_b32 a110, v82
    v_accvgpr_write_b32 a111, v83
    s_mul_i32 s61, s2, 12
    s_mul_i32 s62, s60, 3
    s_add_u32 s61, s61, s62
    s_add_u32 s61, s61, 2
    s_lshr_b32 s62, s61, 8
    s_and_b32 s61, s61, 255
    s_lshl_b32 s61, s61, 5
    s_lshl_b32 s62, s62, 1
    s_add_u32 s62, s62, 20
    s_cmp_eq_u32 s62, 20
    s_cselect_b32 s64, s20, s22
    s_cselect_b32 s65, s21, s23
    s_cmp_eq_u32 s62, 24
    s_cselect_b32 s64, s24, s64
    s_cselect_b32 s65, s25, s65
    s_add_u32 s64, s64, s61
    s_addc_u32 s65, s65, 0
    global_load_dwordx4 v[16:19], v5, s[64:65] offset:0
    v_add_u32 v5, 0x40000, v5
    global_load_dwordx4 v[20:23], v5, s[64:65] offset:0
    v_add_u32 v5, 0x40000, v5
    global_load_dwordx4 v[24:27], v5, s[64:65] offset:0
    v_add_u32 v5, 0x40000, v5
    global_load_dwordx4 v[28:31], v5, s[64:65] offset:0
    v_add_u32 v5, 0x40000, v5
    global_load_dwordx4 v[32:35], v5, s[64:65] offset:0
    v_add_u32 v5, 0x40000, v5
    global_load_dwordx4 v[36:39], v5, s[64:65] offset:0
    v_add_u32 v5, 0x40000, v5
    global_load_dwordx4 v[40:43], v5, s[64:65] offset:0
    v_add_u32 v5, 0x40000, v5
    global_load_dwordx4 v[44:47], v5, s[64:65] offset:0
    v_add_u32 v5, 0x40000, v5
    global_load_dwordx4 v[48:51], v5, s[64:65] offset:0
    v_add_u32 v5, 0x40000, v5
    global_load_dwordx4 v[52:55], v5, s[64:65] offset:0
    v_add_u32 v5, 0x40000, v5
    global_load_dwordx4 v[56:59], v5, s[64:65] offset:0
    v_add_u32 v5, 0x40000, v5
    global_load_dwordx4 v[60:63], v5, s[64:65] offset:0
    v_add_u32 v5, 0x40000, v5
    global_load_dwordx4 v[64:67], v5, s[64:65] offset:0
    v_add_u32 v5, 0x40000, v5
    global_load_dwordx4 v[68:71], v5, s[64:65] offset:0
    v_add_u32 v5, 0x40000, v5
    v_subrev_u32 v5, 0x380000, v5
    s_waitcnt vmcnt(0)
    ds_write_b128 v7, v[16:19] offset:0
    ds_write_b128 v7, v[20:23] offset:1024
    ds_write_b128 v7, v[24:27] offset:2048
    ds_write_b128 v7, v[28:31] offset:3072
    ds_write_b128 v7, v[32:35] offset:4096
    ds_write_b128 v7, v[36:39] offset:5120
    ds_write_b128 v7, v[40:43] offset:6144
    ds_write_b128 v7, v[44:47] offset:7168
    ds_write_b128 v7, v[48:51] offset:8192
    ds_write_b128 v7, v[52:55] offset:9216
    ds_write_b128 v7, v[56:59] offset:10240
    ds_write_b128 v7, v[60:63] offset:11264
    ds_write_b128 v7, v[64:67] offset:12288
    ds_write_b128 v7, v[68:71] offset:13312
    s_waitcnt lgkmcnt(0)
    ds_read_b64_tr_b16 v[80:81], v10 offset:0
    ds_read_b64_tr_b16 v[82:83], v10 offset:128
    s_waitcnt lgkmcnt(0)
    v_accvgpr_write_b32 a112, v80
    v_accvgpr_write_b32 a113, v81
    v_accvgpr_write_b32 a114, v82
    v_accvgpr_write_b32 a115, v83
    ds_read_b64_tr_b16 v[80:81], v10 offset:1024
    ds_read_b64_tr_b16 v[82:83], v10 offset:1152
    s_waitcnt lgkmcnt(0)
    v_accvgpr_write_b32 a116, v80
    v_accvgpr_write_b32 a117, v81
    v_accvgpr_write_b32 a118, v82
    v_accvgpr_write_b32 a119, v83
    ds_read_b64_tr_b16 v[80:81], v10 offset:2048
    ds_read_b64_tr_b16 v[82:83], v10 offset:2176
    s_waitcnt lgkmcnt(0)
    v_accvgpr_write_b32 a120, v80
    v_accvgpr_write_b32 a121, v81
    v_accvgpr_write_b32 a122, v82
    v_accvgpr_write_b32 a123, v83
    ds_read_b64_tr_b16 v[80:81], v10 offset:3072
    ds_read_b64_tr_b16 v[82:83], v10 offset:3200
    s_waitcnt lgkmcnt(0)
    v_accvgpr_write_b32 a124, v80
    v_accvgpr_write_b32 a125, v81
    v_accvgpr_write_b32 a126, v82
    v_accvgpr_write_b32 a127, v83
    ds_read_b64_tr_b16 v[80:81], v10 offset:4096
    ds_read_b64_tr_b16 v[82:83], v10 offset:4224
    s_waitcnt lgkmcnt(0)
    v_accvgpr_write_b32 a128, v80
    v_accvgpr_write_b32 a129, v81
    v_accvgpr_write_b32 a130, v82
    v_accvgpr_write_b32 a131, v83
    ds_read_b64_tr_b16 v[80:81], v10 offset:5120
    ds_read_b64_tr_b16 v[82:83], v10 offset:5248
    s_waitcnt lgkmcnt(0)
    v_accvgpr_write_b32 a132, v80
    v_accvgpr_write_b32 a133, v81
    v_accvgpr_write_b32 a134, v82
    v_accvgpr_write_b32 a135, v83
    ds_read_b64_tr_b16 v[80:81], v10 offset:6144
    ds_read_b64_tr_b16 v[82:83], v10 offset:6272
    s_waitcnt lgkmcnt(0)
    v_accvgpr_write_b32 a136, v80
    v_accvgpr_write_b32 a137, v81
    v_accvgpr_write_b32 a138, v82
    v_accvgpr_write_b32 a139, v83
    ds_read_b64_tr_b16 v[80:81], v10 offset:7168
    ds_read_b64_tr_b16 v[82:83], v10 offset:7296
    s_waitcnt lgkmcnt(0)
    v_accvgpr_write_b32 a140, v80
    v_accvgpr_write_b32 a141, v81
    v_accvgpr_write_b32 a142, v82
    v_accvgpr_write_b32 a143, v83
    ds_read_b64_tr_b16 v[80:81], v10 offset:8192
    ds_read_b64_tr_b16 v[82:83], v10 offset:8320
    s_waitcnt lgkmcnt(0)
    v_accvgpr_write_b32 a144, v80
    v_accvgpr_write_b32 a145, v81
    v_accvgpr_write_b32 a146, v82
    v_accvgpr_write_b32 a147, v83
    ds_read_b64_tr_b16 v[80:81], v10 offset:9216
    ds_read_b64_tr_b16 v[82:83], v10 offset:9344
    s_waitcnt lgkmcnt(0)
    v_accvgpr_write_b32 a148, v80
    v_accvgpr_write_b32 a149, v81
    v_accvgpr_write_b32 a150, v82
    v_accvgpr_write_b32 a151, v83
    ds_read_b64_tr_b16 v[80:81], v10 offset:10240
    ds_read_b64_tr_b16 v[82:83], v10 offset:10368
    s_waitcnt lgkmcnt(0)
    v_accvgpr_write_b32 a152, v80
    v_accvgpr_write_b32 a153, v81
    v_accvgpr_write_b32 a154, v82
    v_accvgpr_write_b32 a155, v83
    ds_read_b64_tr_b16 v[80:81], v10 offset:11264
    ds_read_b64_tr_b16 v[82:83], v10 offset:11392
    s_waitcnt lgkmcnt(0)
    v_accvgpr_write_b32 a156, v80
    v_accvgpr_write_b32 a157, v81
    v_accvgpr_write_b32 a158, v82
    v_accvgpr_write_b32 a159, v83
    ds_read_b64_tr_b16 v[80:81], v10 offset:12288
    ds_read_b64_tr_b16 v[82:83], v10 offset:12416
    s_waitcnt lgkmcnt(0)
    v_accvgpr_write_b32 a160, v80
    v_accvgpr_write_b32 a161, v81
    v_accvgpr_write_b32 a162, v82
    v_accvgpr_write_b32 a163, v83
    ds_read_b64_tr_b16 v[80:81], v10 offset:13312
    ds_read_b64_tr_b16 v[82:83], v10 offset:13440
    s_waitcnt lgkmcnt(0)
    v_accvgpr_write_b32 a164, v80
    v_accvgpr_write_b32 a165, v81
    v_accvgpr_write_b32 a166, v82
    v_accvgpr_write_b32 a167, v83
    s_lshr_b32 s66, s2, 2
    s_and_b32 s67, s2, 3
    s_add_u32 s61, s60, 0
    s_min_u32 s61, s61, 6
    s_lshl_b32 s61, s61, 5
    s_mul_i32 s62, s67, 224
    s_add_u32 s61, s61, s62
    s_mul_i32 s62, s66, 229376
    s_add_u32 s61, s61, s62
    s_add_u32 s64, s26, s61
    s_addc_u32 s65, s27, 0
    v_mul_u32_u24 v5, 896, v3
    v_lshl_add_u32 v5, v4, 4, v5
    global_load_dwordx4 v[16:19], v5, s[64:65] offset:0
    v_add_u32 v5, 28672, v5
    global_load_dwordx4 v[20:23], v5, s[64:65] offset:0
    v_add_u32 v5, 28672, v5
    global_load_dwordx4 v[24:27], v5, s[64:65] offset:0
    v_add_u32 v5, 28672, v5
    global_load_dwordx4 v[28:31], v5, s[64:65] offset:0
    v_add_u32 v5, 28672, v5
    global_load_dwordx4 v[32:35], v5, s[64:65] offset:0
    v_add_u32 v5, 28672, v5
    global_load_dwordx4 v[36:39], v5, s[64:65] offset:0
    v_add_u32 v5, 28672, v5
    global_load_dwordx4 v[40:43], v5, s[64:65] offset:0
    v_add_u32 v5, 28672, v5
    global_load_dwordx4 v[44:47], v5, s[64:65] offset:0
    v_add_u32 v5, 28672, v5
    s_waitcnt vmcnt(0)
    ds_write_b128 v7, v[16:19] offset:0
    ds_write_b128 v7, v[20:23] offset:1024
    ds_write_b128 v7, v[24:27] offset:2048
    ds_write_b128 v7, v[28:31] offset:3072
    ds_write_b128 v7, v[32:35] offset:4096
    ds_write_b128 v7, v[36:39] offset:5120
    ds_write_b128 v7, v[40:43] offset:6144
    ds_write_b128 v7, v[44:47] offset:7168
    s_waitcnt lgkmcnt(0)
    ds_read_b64_tr_b16 v[80:81], v10 offset:0
    ds_read_b64_tr_b16 v[82:83], v10 offset:128
    s_waitcnt lgkmcnt(0)
    v_accvgpr_write_b32 a168, v80
    v_accvgpr_write_b32 a169, v81
    v_accvgpr_write_b32 a170, v82
    v_accvgpr_write_b32 a171, v83
    ds_read_b64_tr_b16 v[80:81], v10 offset:1024
    ds_read_b64_tr_b16 v[82:83], v10 offset:1152
    s_waitcnt lgkmcnt(0)
    v_accvgpr_write_b32 a172, v80
    v_accvgpr_write_b32 a173, v81
    v_accvgpr_write_b32 a174, v82
    v_accvgpr_write_b32 a175, v83
    ds_read_b64_tr_b16 v[80:81], v10 offset:2048
    ds_read_b64_tr_b16 v[82:83], v10 offset:2176
    s_waitcnt lgkmcnt(0)
    v_accvgpr_write_b32 a176, v80
    v_accvgpr_write_b32 a177, v81
    v_accvgpr_write_b32 a178, v82
    v_accvgpr_write_b32 a179, v83
    ds_read_b64_tr_b16 v[80:81], v10 offset:3072
    ds_read_b64_tr_b16 v[82:83], v10 offset:3200
    s_waitcnt lgkmcnt(0)
    v_accvgpr_write_b32 a180, v80
    v_accvgpr_write_b32 a181, v81
    v_accvgpr_write_b32 a182, v82
    v_accvgpr_write_b32 a183, v83
    ds_read_b64_tr_b16 v[80:81], v10 offset:4096
    ds_read_b64_tr_b16 v[82:83], v10 offset:4224
    s_waitcnt lgkmcnt(0)
    v_accvgpr_write_b32 a184, v80
    v_accvgpr_write_b32 a185, v81
    v_accvgpr_write_b32 a186, v82
    v_accvgpr_write_b32 a187, v83
    ds_read_b64_tr_b16 v[80:81], v10 offset:5120
    ds_read_b64_tr_b16 v[82:83], v10 offset:5248
    s_waitcnt lgkmcnt(0)
    v_accvgpr_write_b32 a188, v80
    v_accvgpr_write_b32 a189, v81
    v_accvgpr_write_b32 a190, v82
    v_accvgpr_write_b32 a191, v83
    ds_read_b64_tr_b16 v[80:81], v10 offset:6144
    ds_read_b64_tr_b16 v[82:83], v10 offset:6272
    s_waitcnt lgkmcnt(0)
    v_accvgpr_write_b32 a192, v80
    v_accvgpr_write_b32 a193, v81
    v_accvgpr_write_b32 a194, v82
    v_accvgpr_write_b32 a195, v83
    ds_read_b64_tr_b16 v[80:81], v10 offset:7168
    ds_read_b64_tr_b16 v[82:83], v10 offset:7296
    s_waitcnt lgkmcnt(0)
    v_accvgpr_write_b32 a196, v80
    v_accvgpr_write_b32 a197, v81
    v_accvgpr_write_b32 a198, v82
    v_accvgpr_write_b32 a199, v83
    s_add_u32 s61, s60, 4
    s_min_u32 s61, s61, 6
    s_lshl_b32 s61, s61, 5
    s_mul_i32 s62, s67, 224
    s_add_u32 s61, s61, s62
    s_mul_i32 s62, s66, 229376
    s_add_u32 s61, s61, s62
    s_add_u32 s64, s26, s61
    s_addc_u32 s65, s27, 0
    v_mul_u32_u24 v5, 896, v3
    v_lshl_add_u32 v5, v4, 4, v5
    global_load_dwordx4 v[16:19], v5, s[64:65] offset:0
    v_add_u32 v5, 28672, v5
    global_load_dwordx4 v[20:23], v5, s[64:65] offset:0
    v_add_u32 v5, 28672, v5
    global_load_dwordx4 v[24:27], v5, s[64:65] offset:0
    v_add_u32 v5, 28672, v5
    global_load_dwordx4 v[28:31], v5, s[64:65] offset:0
    v_add_u32 v5, 28672, v5
    global_load_dwordx4 v[32:35], v5, s[64:65] offset:0
    v_add_u32 v5, 28672, v5
    global_load_dwordx4 v[36:39], v5, s[64:65] offset:0
    v_add_u32 v5, 28672, v5
    global_load_dwordx4 v[40:43], v5, s[64:65] offset:0
    v_add_u32 v5, 28672, v5
    global_load_dwordx4 v[44:47], v5, s[64:65] offset:0
    v_add_u32 v5, 28672, v5
    s_waitcnt vmcnt(0)
    ds_write_b128 v7, v[16:19] offset:0
    ds_write_b128 v7, v[20:23] offset:1024
    ds_write_b128 v7, v[24:27] offset:2048
    ds_write_b128 v7, v[28:31] offset:3072
    ds_write_b128 v7, v[32:35] offset:4096
    ds_write_b128 v7, v[36:39] offset:5120
    ds_write_b128 v7, v[40:43] offset:6144
    ds_write_b128 v7, v[44:47] offset:7168
    s_waitcnt lgkmcnt(0)
    ds_read_b64_tr_b16 v[80:81], v10 offset:0
    ds_read_b64_tr_b16 v[82:83], v10 offset:128
    s_waitcnt lgkmcnt(0)
    v_accvgpr_write_b32 a200, v80
    v_accvgpr_write_b32 a201, v81
    v_accvgpr_write_b32 a202, v82
    v_accvgpr_write_b32 a203, v83
    ds_read_b64_tr_b16 v[80:81], v10 offset:1024
    ds_read_b64_tr_b16 v[82:83], v10 offset:1152
    s_waitcnt lgkmcnt(0)
    v_accvgpr_write_b32 a204, v80
    v_accvgpr_write_b32 a205, v81
    v_accvgpr_write_b32 a206, v82
    v_accvgpr_write_b32 a207, v83
    ds_read_b64_tr_b16 v[80:81], v10 offset:2048
    ds_read_b64_tr_b16 v[82:83], v10 offset:2176
    s_waitcnt lgkmcnt(0)
    v_accvgpr_write_b32 a208, v80
    v_accvgpr_write_b32 a209, v81
    v_accvgpr_write_b32 a210, v82
    v_accvgpr_write_b32 a211, v83
    ds_read_b64_tr_b16 v[80:81], v10 offset:3072
    ds_read_b64_tr_b16 v[82:83], v10 offset:3200
    s_waitcnt lgkmcnt(0)
    v_accvgpr_write_b32 a212, v80
    v_accvgpr_write_b32 a213, v81
    v_accvgpr_write_b32 a214, v82
    v_accvgpr_write_b32 a215, v83
    ds_read_b64_tr_b16 v[80:81], v10 offset:4096
    ds_read_b64_tr_b16 v[82:83], v10 offset:4224
    s_waitcnt lgkmcnt(0)
    v_accvgpr_write_b32 a216, v80
    v_accvgpr_write_b32 a217, v81
    v_accvgpr_write_b32 a218, v82
    v_accvgpr_write_b32 a219, v83
    ds_read_b64_tr_b16 v[80:81], v10 offset:5120
    ds_read_b64_tr_b16 v[82:83], v10 offset:5248
    s_waitcnt lgkmcnt(0)
    v_accvgpr_write_b32 a220, v80
    v_accvgpr_write_b32 a221, v81
    v_accvgpr_write_b32 a222, v82
    v_accvgpr_write_b32 a223, v83
    ds_read_b64_tr_b16 v[80:81], v10 offset:6144
    ds_read_b64_tr_b16 v[82:83], v10 offset:6272
    s_waitcnt lgkmcnt(0)
    v_accvgpr_write_b32 a224, v80
    v_accvgpr_write_b32 a225, v81
    v_accvgpr_write_b32 a226, v82
    v_accvgpr_write_b32 a227, v83
    ds_read_b64_tr_b16 v[80:81], v10 offset:7168
    ds_read_b64_tr_b16 v[82:83], v10 offset:7296
    s_waitcnt lgkmcnt(0)
    v_accvgpr_write_b32 a228, v80
    v_accvgpr_write_b32 a229, v81
    v_accvgpr_write_b32 a230, v82
    v_accvgpr_write_b32 a231, v83
    s_barrier
    v_mov_b32 v16, 0
    v_mov_b32 v17, 0
    v_mov_b32 v18, 0
    v_mov_b32 v19, 0
    v_lshlrev_b32 v5, 4, v0
    ds_write_b128 v5, v[16:19]
    v_add_u32 v5, 4096, v5
    ds_write_b128 v5, v[16:19]
    v_add_u32 v5, 4096, v5
    ds_write_b128 v5, v[16:19]
    v_add_u32 v5, 4096, v5
    ds_write_b128 v5, v[16:19]
    v_add_u32 v5, 4096, v5
    ds_write_b128 v5, v[16:19]
    v_add_u32 v5, 4096, v5
    ds_write_b128 v5, v[16:19]
    v_add_u32 v5, 4096, v5
    ds_write_b128 v5, v[16:19]
    v_add_u32 v5, 4096, v5
    ds_write_b128 v5, v[16:19]
    v_add_u32 v5, 4096, v5
    ds_write_b128 v5, v[16:19]
    v_add_u32 v5, 4096, v5
    ds_write_b128 v5, v[16:19]
    v_add_u32 v5, 4096, v5
    ds_write_b128 v5, v[16:19]
    v_add_u32 v5, 4096, v5
    ds_write_b128 v5, v[16:19]
    v_add_u32 v5, 4096, v5
    ds_write_b128 v5, v[16:19]
    v_add_u32 v5, 4096, v5
    ds_write_b128 v5, v[16:19]
    v_add_u32 v5, 4096, v5
    ds_write_b128 v5, v[16:19]
    v_add_u32 v5, 4096, v5
    ds_write_b128 v5, v[16:19]
    v_add_u32 v5, 4096, v5
    ds_write_b128 v5, v[16:19]
    v_add_u32 v5, 4096, v5
    ds_write_b128 v5, v[16:19]
    v_add_u32 v5, 4096, v5
    ds_write_b128 v5, v[16:19]
    v_add_u32 v5, 4096, v5
    ds_write_b128 v5, v[16:19]
    v_add_u32 v5, 4096, v5
    ds_write_b128 v5, v[16:19]
    v_add_u32 v5, 4096, v5
    ds_write_b128 v5, v[16:19]
    v_add_u32 v5, 4096, v5
    ds_write_b128 v5, v[16:19]
    v_add_u32 v5, 4096, v5
    ds_write_b128 v5, v[16:19]
    v_add_u32 v5, 4096, v5
    ds_write_b128 v5, v[16:19]
    v_add_u32 v5, 4096, v5
    s_waitcnt lgkmcnt(0)
    s_barrier
    v_and_b32 v11, 15, v1
    v_lshrrev_b32 v12, 4, v1
    v_mov_b32 v13, 0
    s_mov_b32 s68, 0
cloop_17:
    s_cmp_eq_u32 s68, 0
    s_cbranch_scc1 cskipw_18
    s_cmp_lg_u32 s60, 0
    s_cbranch_scc1 polld_20
    v_lshlrev_b32 v14, 2, v1
    v_add_u32 v14, 147734784, v14
poll_19:
    global_load_dword v15, v14, s[46:47] sc1
    s_waitcnt vmcnt(0)
    v_cmp_le_u32 vcc, s68, v15
    s_nop 1
    s_cmp_eq_u64 vcc, exec
    s_cbranch_scc1 polld_20
    s_branch poll_19
polld_20:
    s_barrier
cskipw_18:
    s_cmp_eq_u32 s68, 0
    s_cbranch_scc1 cmem0_21
    s_mul_i32 s61, s68, 14336
    s_add_u32 s61, s61, 146800640
    v_add_u32 v5, 0, v0
    v_cmp_gt_u32 vcc, 896, v5
    s_and_saveexec_b64 s[70:71], vcc
    v_lshlrev_b32 v6, 4, v5
    v_add_u32 v6, s61, v6
    global_load_dwordx4 v[64:67], v6, s[46:47] sc1
    s_mov_b64 exec, s[70:71]
    v_add_u32 v5, 256, v0
    v_cmp_gt_u32 vcc, 896, v5
    s_and_saveexec_b64 s[70:71], vcc
    v_lshlrev_b32 v6, 4, v5
    v_add_u32 v6, s61, v6
    global_load_dwordx4 v[68:71], v6, s[46:47] sc1
    s_mov_b64 exec, s[70:71]
    v_add_u32 v5, 512, v0
    v_cmp_gt_u32 vcc, 896, v5
    s_and_saveexec_b64 s[70:71], vcc
    v_lshlrev_b32 v6, 4, v5
    v_add_u32 v6, s61, v6
    global_load_dwordx4 v[72:75], v6, s[46:47] sc1
    s_mov_b64 exec, s[70:71]
    v_add_u32 v5, 768, v0
    v_cmp_gt_u32 vcc, 896, v5
    s_and_saveexec_b64 s[70:71], vcc
    v_lshlrev_b32 v6, 4, v5
    v_add_u32 v6, s61, v6
    global_load_dwordx4 v[76:79], v6, s[46:47] sc1
    s_mov_b64 exec, s[70:71]
    v_add_u32 v5, 0, v0
    v_cmp_gt_u32 vcc, 896, v5
    s_and_saveexec_b64 s[70:71], vcc
    v_mul_u32_u24 v7, 0x4925, v5
    v_lshrrev_b32 v7, 21, v7
    v_mul_u32_u24 v8, 112, v7
    v_sub_u32 v8, v5, v8
    v_mul_u32_u24 v7, 912, v7
    v_lshl_add_u32 v7, v8, 3, v7
    s_waitcnt vmcnt(3)
    v_cvt_pk_bf16_f32 v16, v64, v65
    v_cvt_pk_bf16_f32 v17, v66, v67
    ds_write_b64 v7, v[16:17] offset:16896
    s_mov_b64 exec, s[70:71]
    v_add_u32 v5, 256, v0
    v_cmp_gt_u32 vcc, 896, v5
    s_and_saveexec_b64 s[70:71], vcc
    v_mul_u32_u24 v7, 0x4925, v5
    v_lshrrev_b32 v7, 21, v7
    v_mul_u32_u24 v8, 112, v7
    v_sub_u32 v8, v5, v8
    v_mul_u32_u24 v7, 912, v7
    v_lshl_add_u32 v7, v8, 3, v7
    s_waitcnt vmcnt(2)
    v_cvt_pk_bf16_f32 v16, v68, v69
    v_cvt_pk_bf16_f32 v17, v70, v71
    ds_write_b64 v7, v[16:17] offset:16896
    s_mov_b64 exec, s[70:71]
    v_add_u32 v5, 512, v0
    v_cmp_gt_u32 vcc, 896, v5
    s_and_saveexec_b64 s[70:71], vcc
    v_mul_u32_u24 v7, 0x4925, v5
    v_lshrrev_b32 v7, 21, v7
    v_mul_u32_u24 v8, 112, v7
    v_sub_u32 v8, v5, v8
    v_mul_u32_u24 v7, 912, v7
    v_lshl_add_u32 v7, v8, 3, v7
    s_waitcnt vmcnt(1)
    v_cvt_pk_bf16_f32 v16, v72, v73
    v_cvt_pk_bf16_f32 v17, v74, v75
    ds_write_b64 v7, v[16:17] offset:16896
    s_mov_b64 exec, s[70:71]
    v_add_u32 v5, 768, v0
    v_cmp_gt_u32 vcc, 896, v5
    s_and_saveexec_b64 s[70:71], vcc
    v_mul_u32_u24 v7, 0x4925, v5
    v_lshrrev_b32 v7, 21, v7
    v_mul_u32_u24 v8, 112, v7
    v_sub_u32 v8, v5, v8
    v_mul_u32_u24 v7, 912, v7
    v_lshl_add_u32 v7, v8, 3, v7
    s_waitcnt vmcnt(0)
    v_cvt_pk_bf16_f32 v16, v76, v77
    v_cvt_pk_bf16_f32 v17, v78, v79
    ds_write_b64 v7, v[16:17] offset:16896
    s_mov_b64 exec, s[70:71]
    s_branch cmemd_22
cmem0_21:
    v_add_u32 v5, 0, v0
    v_cmp_gt_u32 vcc, 448, v5
    s_and_saveexec_b64 s[70:71], vcc
    v_lshlrev_b32 v6, 4, v5
    global_load_dwordx4 v[16:19], v6, s[18:19]
    v_mul_u32_u24 v7, 0x2493, v5
    v_lshrrev_b32 v7, 19, v7
    v_mul_u32_u24 v8, 56, v7
    v_sub_u32 v8, v5, v8
    v_mul_u32_u24 v7, 912, v7
    v_lshl_add_u32 v7, v8, 4, v7
    s_waitcnt vmcnt(0)
    ds_write_b128 v7, v[16:19] offset:16896
    s_mov_b64 exec, s[70:71]
    v_add_u32 v5, 256, v0
    v_cmp_gt_u32 vcc, 448, v5
    s_and_saveexec_b64 s[70:71], vcc
    v_lshlrev_b32 v6, 4, v5
    global_load_dwordx4 v[16:19], v6, s[18:19]
    v_mul_u32_u24 v7, 0x2493, v5
    v_lshrrev_b32 v7, 19, v7
    v_mul_u32_u24 v8, 56, v7
    v_sub_u32 v8, v5, v8
    v_mul_u32_u24 v7, 912, v7
    v_lshl_add_u32 v7, v8, 4, v7
    s_waitcnt vmcnt(0)
    ds_write_b128 v7, v[16:19] offset:16896
    s_mov_b64 exec, s[70:71]
cmemd_22:
    s_waitcnt lgkmcnt(0)
    s_barrier
    v_mul_u32_u24 v5, 912, v11
    v_lshl_add_u32 v5, v12, 4, v5
    v_mov_b32 v32, 0
    v_mov_b32 v33, 0
    v_mov_b32 v34, 0
    v_mov_b32 v35, 0
    v_mov_b32 v36, 0
    v_mov_b32 v37, 0
    v_mov_b32 v38, 0
    v_mov_b32 v39, 0
    v_mov_b32 v40, 0
    v_mov_b32 v41, 0
    v_mov_b32 v42, 0
    v_mov_b32 v43, 0
    ds_read_b128 v[64:67], v5 offset:16896
    ds_read_b128 v[68:71], v5 offset:16960
    ds_read_b128 v[72:75], v5 offset:17024
    ds_read_b128 v[76:79], v5 offset:17088
    ds_read_b128 v[80:83], v5 offset:17152
    ds_read_b128 v[84:87], v5 offset:17216
    ds_read_b128 v[88:91], v5 offset:17280
    ds_read_b128 v[92:95], v5 offset:17344
    ds_read_b128 v[96:99], v5 offset:17408
    ds_read_b128 v[100:103], v5 offset:17472
    ds_read_b128 v[104:107], v5 offset:17536
    ds_read_b128 v[108:111], v5 offset:17600
    ds_read_b128 v[112:115], v5 offset:17664
    ds_read_b128 v[116:119], v5 offset:17728
    s_waitcnt lgkmcnt(13)
    v_mfma_f32_16x16x32_bf16 v[32:35], a[0:3], v[64:67], v[32:35]
    v_mfma_f32_16x16x32_bf16 v[36:39], a[56:59], v[64:67], v[36:39]
    v_mfma_f32_16x16x32_bf16 v[40:43], a[112:115], v[64:67], v[40:43]
    s_waitcnt lgkmcnt(12)
    v_mfma_f32_16x16x32_bf16 v[32:35], a[4:7], v[68:71], v[32:35]
    v_mfma_f32_16x16x32_bf16 v[36:39], a[60:63], v[68:71], v[36:39]
    v_mfma_f32_16x16x32_bf16 v[40:43], a[116:119], v[68:71], v[40:43]
    s_waitcnt lgkmcnt(11)
    v_mfma_f32_16x16x32_bf16 v[32:35], a[8:11], v[72:75], v[32:35]
    v_mfma_f32_16x16x32_bf16 v[36:39], a[64:67], v[72:75], v[36:39]
    v_mfma_f32_16x16x32_bf16 v[40:43], a[120:123], v[72:75], v[40:43]
    s_waitcnt lgkmcnt(10)
    v_mfma_f32_16x16x32_bf16 v[32:35], a[12:15], v[76:79], v[32:35]
    v_mfma_f32_16x16x32_bf16 v[36:39], a[68:71], v[76:79], v[36:39]
    v_mfma_f32_16x16x32_bf16 v[40:43], a[124:127], v[76:79], v[40:43]
    s_waitcnt lgkmcnt(9)
    v_mfma_f32_16x16x32_bf16 v[32:35], a[16:19], v[80:83], v[32:35]
    v_mfma_f32_16x16x32_bf16 v[36:39], a[72:75], v[80:83], v[36:39]
    v_mfma_f32_16x16x32_bf16 v[40:43], a[128:131], v[80:83], v[40:43]
    s_waitcnt lgkmcnt(8)
    v_mfma_f32_16x16x32_bf16 v[32:35], a[20:23], v[84:87], v[32:35]
    v_mfma_f32_16x16x32_bf16 v[36:39], a[76:79], v[84:87], v[36:39]
    v_mfma_f32_16x16x32_bf16 v[40:43], a[132:135], v[84:87], v[40:43]
    s_waitcnt lgkmcnt(7)
    v_mfma_f32_16x16x32_bf16 v[32:35], a[24:27], v[88:91], v[32:35]
    v_mfma_f32_16x16x32_bf16 v[36:39], a[80:83], v[88:91], v[36:39]
    v_mfma_f32_16x16x32_bf16 v[40:43], a[136:139], v[88:91], v[40:43]
    s_waitcnt lgkmcnt(6)
    v_mfma_f32_16x16x32_bf16 v[32:35], a[28:31], v[92:95], v[32:35]
    v_mfma_f32_16x16x32_bf16 v[36:39], a[84:87], v[92:95], v[36:39]
    v_mfma_f32_16x16x32_bf16 v[40:43], a[140:143], v[92:95], v[40:43]
    s_waitcnt lgkmcnt(5)
    v_mfma_f32_16x16x32_bf16 v[32:35], a[32:35], v[96:99], v[32:35]
    v_mfma_f32_16x16x32_bf16 v[36:39], a[88:91], v[96:99], v[36:39]
    v_mfma_f32_16x16x32_bf16 v[40:43], a[144:147], v[96:99], v[40:43]
    s_waitcnt lgkmcnt(4)
    v_mfma_f32_16x16x32_bf16 v[32:35], a[36:39], v[100:103], v[32:35]
    v_mfma_f32_16x16x32_bf16 v[36:39], a[92:95], v[100:103], v[36:39]
    v_mfma_f32_16x16x32_bf16 v[40:43], a[148:151], v[100:103], v[40:43]
    s_waitcnt lgkmcnt(3)
    v_mfma_f32_16x16x32_bf16 v[32:35], a[40:43], v[104:107], v[32:35]
    v_mfma_f32_16x16x32_bf16 v[36:39], a[96:99], v[104:107], v[36:39]
    v_mfma_f32_16x16x32_bf16 v[40:43], a[152:155], v[104:107], v[40:43]
    s_waitcnt lgkmcnt(2)
    v_mfma_f32_16x16x32_bf16 v[32:35], a[44:47], v[108:111], v[32:35]
    v_mfma_f32_16x16x32_bf16 v[36:39], a[100:103], v[108:111], v[36:39]
    v_mfma_f32_16x16x32_bf16 v[40:43], a[156:159], v[108:111], v[40:43]
    s_waitcnt lgkmcnt(1)
    v_mfma_f32_16x16x32_bf16 v[32:35], a[48:51], v[112:115], v[32:35]
    v_mfma_f32_16x16x32_bf16 v[36:39], a[104:107], v[112:115], v[36:39]
    v_mfma_f32_16x16x32_bf16 v[40:43], a[160:163], v[112:115], v[40:43]
    s_waitcnt lgkmcnt(0)
    v_mfma_f32_16x16x32_bf16 v[32:35], a[52:55], v[116:119], v[32:35]
    v_mfma_f32_16x16x32_bf16 v[36:39], a[108:111], v[116:119], v[36:39]
    v_mfma_f32_16x16x32_bf16 v[40:43], a[164:167], v[116:119], v[40:43]
    s_nop 7
    s_nop 7
    s_mul_i32 s61, s68, 196608
    s_add_u32 s61, s61, 134217728
    s_mul_i32 s62, s2, 12
    s_mul_i32 s63, s60, 3
    s_add_u32 s62, s62, s63
    s_lshl_b32 s62, s62, 5
    s_add_u32 s61, s61, s62
    v_mul_u32_u24 v6, 24576, v11
    v_lshl_add_u32 v6, v12, 3, v6
    v_add_u32 v6, s61, v6
    v_cmp_gt_u32 vcc, 8, v11
    s_and_saveexec_b64 s[70:71], vcc
    v_cvt_pk_bf16_f32 v20, v32, v33
    v_cvt_pk_bf16_f32 v21, v34, v35
    global_store_dwordx2 v6, v[20:21], s[46:47] offset:0 sc1
    v_cvt_pk_bf16_f32 v22, v36, v37
    v_cvt_pk_bf16_f32 v23, v38, v39
    global_store_dwordx2 v6, v[22:23], s[46:47] offset:32 sc1
    v_cvt_pk_bf16_f32 v24, v40, v41
    v_cvt_pk_bf16_f32 v25, v42, v43
    global_store_dwordx2 v6, v[24:25], s[46:47] offset:64 sc1
    s_mov_b64 exec, s[70:71]
    s_waitcnt vmcnt(0)
    s_barrier
    v_cmp_eq_u32 vcc, 0, v0
    s_and_saveexec_b64 s[70:71], vcc
    s_cbranch_execz post_23
    s_add_u32 s61, s68, 1
    v_mov_b32 v15, s61
    s_lshl_b32 s62, s2, 2
    v_mov_b32 v14, s62
    v_add_u32 v14, 147734528, v14
    global_store_dword v14, v15, s[46:47] sc1
post_23:
    s_mov_b64 exec, s[70:71]
    s_mul_i32 s61, s68, 786432
    s_lshl_b32 s62, s66, 9
    s_add_u32 s61, s61, s62
    v_lshrrev_b32 v5, 5, v0
    v_and_b32 v6, 31, v0
    v_mul_u32_u24 v7, 24576, v5
    v_lshl_add_u32 v7, v6, 4, v7
    v_add_u32 v7, s61, v7
    v_add_u32 v7, 8192, v7
    global_load_dwordx4 v[64:67], v7, s[46:47] offset:0
    v_add_u32 v7, 196608, v7
    global_load_dwordx4 v[68:71], v7, s[46:47] offset:0
    v_add_u32 v7, 196608, v7
    global_load_dwordx4 v[72:75], v7, s[46:47] offset:0
    v_add_u32 v7, 196608, v7
    global_load_dwordx4 v[76:79], v7, s[46:47] offset:0
    v_add_u32 v7, 196608, v7
    v_subrev_u32 v7, 778240, v7
    global_load_dwordx4 v[80:83], v7, s[46:47] offset:0
    v_add_u32 v7, 196608, v7
    global_load_dwordx4 v[84:87], v7, s[46:47] offset:0
    v_add_u32 v7, 196608, v7
    global_load_dwordx4 v[88:91], v7, s[46:47] offset:0
    v_add_u32 v7, 196608, v7
    global_load_dwordx4 v[92:95], v7, s[46:47] offset:0
    v_add_u32 v7, 196608, v7
    s_add_u32 s69, s68, 1
    s_cmp_lg_u32 s60, 0
    s_cbranch_scc1 polld_25
    v_lshlrev_b32 v14, 2, v1
    v_add_u32 v14, 147734528, v14
poll_24:
    global_load_dword v15, v14, s[46:47] sc1
    s_waitcnt vmcnt(0)
    v_cmp_le_u32 vcc, s69, v15
    s_nop 1
    s_cmp_eq_u64 vcc, exec
    s_cbranch_scc1 polld_25
    s_branch poll_24
polld_25:
    s_barrier
    s_mul_i32 s61, s68, 196608
    s_add_u32 s61, s61, 134217728
    s_add_u32 s61, s61, s62
    v_mul_u32_u24 v7, 24576, v5
    v_lshl_add_u32 v7, v6, 4, v7
    v_add_u32 v7, s61, v7
    global_load_dwordx4 v[96:99], v7, s[46:47] offset:0 sc1
    v_add_u32 v7, 8192, v7
    global_load_dwordx4 v[100:103], v7, s[46:47] offset:0 sc1
    v_add_u32 v7, 8192, v7
    global_load_dwordx4 v[104:107], v7, s[46:47] offset:0 sc1
    v_add_u32 v7, 8192, v7
    s_waitcnt vmcnt(0)
    v_mul_u32_u24 v8, 528, v5
    v_lshl_add_u32 v8, v6, 4, v8
    v_mul_u32_u24 v9, 576, v5
    v_lshl_add_u32 v9, v6, 4, v9
    v_add_u32 v9, 65280, v9
    ds_write_b128 v8, v[96:99] offset:8448
    ds_write_b128 v8, v[100:103] offset:31488
    ds_write_b128 v9, v[104:107] offset:0
    ds_write_b128 v8, v[64:67] offset:35712
    ds_write_b128 v9, v[80:83] offset:4608
    ds_write_b128 v8, v[68:71] offset:39936
    ds_write_b128 v9, v[84:87] offset:9216
    ds_write_b128 v8, v[72:75] offset:44160
    ds_write_b128 v9, v[88:91] offset:13824
    ds_write_b128 v8, v[76:79] offset:48384
    ds_write_b128 v9, v[92:95] offset:18432
    s_waitcnt lgkmcnt(0)
    s_barrier
    v_mul_u32_u24 v5, 528, v11
    v_lshl_add_u32 v5, v12, 4, v5
    v_mov_b32 v32, 0
    v_mov_b32 v33, 0
    v_mov_b32 v34, 0
    v_mov_b32 v35, 0
    v_mov_b32 v36, 0
    v_mov_b32 v37, 0
    v_mov_b32 v38, 0
    v_mov_b32 v39, 0
    v_mov_b32 v40, 0
    v_mov_b32 v41, 0
    v_mov_b32 v42, 0
    v_mov_b32 v43, 0
    ds_read_b128 v[16:19], v5 offset:8448
    ds_read_b128 v[20:23], v5 offset:31488
    ds_read_b128 v[24:27], v5 offset:39936
    ds_read_b128 v[28:31], v5 offset:48384
    s_waitcnt lgkmcnt(0)
    v_mfma_f32_16x16x32_bf16 v[32:35], v[20:23], v[16:19], v[32:35]
    v_mfma_f32_16x16x32_bf16 v[36:39], v[24:27], v[16:19], v[36:39]
    v_mfma_f32_16x16x32_bf16 v[40:43], v[28:31], v[16:19], v[40:43]
    ds_read_b128 v[16:19], v5 offset:8512
    ds_read_b128 v[20:23], v5 offset:31552
    ds_read_b128 v[24:27], v5 offset:40000
    ds_read_b128 v[28:31], v5 offset:48448
    s_waitcnt lgkmcnt(0)
    v_mfma_f32_16x16x32_bf16 v[32:35], v[20:23], v[16:19], v[32:35]
    v_mfma_f32_16x16x32_bf16 v[36:39], v[24:27], v[16:19], v[36:39]
    v_mfma_f32_16x16x32_bf16 v[40:43], v[28:31], v[16:19], v[40:43]
    ds_read_b128 v[16:19], v5 offset:8576
    ds_read_b128 v[20:23], v5 offset:31616
    ds_read_b128 v[24:27], v5 offset:40064
    ds_read_b128 v[28:31], v5 offset:48512
    s_waitcnt lgkmcnt(0)
    v_mfma_f32_16x16x32_bf16 v[32:35], v[20:23], v[16:19], v[32:35]
    v_mfma_f32_16x16x32_bf16 v[36:39], v[24:27], v[16:19], v[36:39]
    v_mfma_f32_16x16x32_bf16 v[40:43], v[28:31], v[16:19], v[40:43]
    ds_read_b128 v[16:19], v5 offset:8640
    ds_read_b128 v[20:23], v5 offset:31680
    ds_read_b128 v[24:27], v5 offset:40128
    ds_read_b128 v[28:31], v5 offset:48576
    s_waitcnt lgkmcnt(0)
    v_mfma_f32_16x16x32_bf16 v[32:35], v[20:23], v[16:19], v[32:35]
    v_mfma_f32_16x16x32_bf16 v[36:39], v[24:27], v[16:19], v[36:39]
    v_mfma_f32_16x16x32_bf16 v[40:43], v[28:31], v[16:19], v[40:43]
    ds_read_b128 v[16:19], v5 offset:8704
    ds_read_b128 v[20:23], v5 offset:31744
    ds_read_b128 v[24:27], v5 offset:40192
    ds_read_b128 v[28:31], v5 offset:48640
    s_waitcnt lgkmcnt(0)
    v_mfma_f32_16x16x32_bf16 v[32:35], v[20:23], v[16:19], v[32:35]
    v_mfma_f32_16x16x32_bf16 v[36:39], v[24:27], v[16:19], v[36:39]
    v_mfma_f32_16x16x32_bf16 v[40:43], v[28:31], v[16:19], v[40:43]
    ds_read_b128 v[16:19], v5 offset:8768
    ds_read_b128 v[20:23], v5 offset:31808
    ds_read_b128 v[24:27], v5 offset:40256
    ds_read_b128 v[28:31], v5 offset:48704
    s_waitcnt lgkmcnt(0)
    v_mfma_f32_16x16x32_bf16 v[32:35], v[20:23], v[16:19], v[32:35]
    v_mfma_f32_16x16x32_bf16 v[36:39], v[24:27], v[16:19], v[36:39]
    v_mfma_f32_16x16x32_bf16 v[40:43], v[28:31], v[16:19], v[40:43]
    ds_read_b128 v[16:19], v5 offset:8832
    ds_read_b128 v[20:23], v5 offset:31872
    ds_read_b128 v[24:27], v5 offset:40320
    ds_read_b128 v[28:31], v5 offset:48768
    s_waitcnt lgkmcnt(0)
    v_mfma_f32_16x16x32_bf16 v[32:35], v[20:23], v[16:19], v[32:35]
    v_mfma_f32_16x16x32_bf16 v[36:39], v[24:27], v[16:19], v[36:39]
    v_mfma_f32_16x16x32_bf16 v[40:43], v[28:31], v[16:19], v[40:43]
    ds_read_b128 v[16:19], v5 offset:8896
    ds_read_b128 v[20:23], v5 offset:31936
    ds_read_b128 v[24:27], v5 offset:40384
    ds_read_b128 v[28:31], v5 offset:48832
    s_waitcnt lgkmcnt(0)
    v_mfma_f32_16x16x32_bf16 v[32:35], v[20:23], v[16:19], v[32:35]
    v_mfma_f32_16x16x32_bf16 v[36:39], v[24:27], v[16:19], v[36:39]
    v_mfma_f32_16x16x32_bf16 v[40:43], v[28:31], v[16:19], v[40:43]
    s_nop 7
    s_nop 7
    v_cmp_gt_u32 vcc, 2, v12
    v_cvt_pk_bf16_f32 v16, v32, v32
    v_lshlrev_b32 v32, 16, v16
    v_mul_f32 v32, 0x3d800000, v32
    v_cvt_pk_bf16_f32 v16, v33, v33
    v_lshlrev_b32 v33, 16, v16
    v_mul_f32 v33, 0x3d800000, v33
    v_cvt_pk_bf16_f32 v16, v34, v34
    v_lshlrev_b32 v34, 16, v16
    v_mul_f32 v34, 0x3d800000, v34
    v_cvt_pk_bf16_f32 v16, v35, v35
    v_lshlrev_b32 v35, 16, v16
    v_mul_f32 v35, 0x3d800000, v35
    v_cvt_pk_bf16_f32 v16, v36, v36
    v_lshlrev_b32 v36, 16, v16
    v_mul_f32 v36, 0x3d800000, v36
    v_cvt_pk_bf16_f32 v16, v37, v37
    v_lshlrev_b32 v37, 16, v16
    v_mul_f32 v37, 0x3d800000, v37
    v_cvt_pk_bf16_f32 v16, v38, v38
    v_lshlrev_b32 v38, 16, v16
    v_mul_f32 v38, 0x3d800000, v38
    v_cvt_pk_bf16_f32 v16, v39, v39
    v_lshlrev_b32 v39, 16, v16
    v_mul_f32 v39, 0x3d800000, v39
    v_cvt_pk_bf16_f32 v16, v40, v40
    v_lshlrev_b32 v40, 16, v16
    v_mul_f32 v40, 0x3d800000, v40
    v_cvt_pk_bf16_f32 v16, v41, v41
    v_lshlrev_b32 v41, 16, v16
    v_mul_f32 v41, 0x3d800000, v41
    v_cvt_pk_bf16_f32 v16, v42, v42
    v_lshlrev_b32 v42, 16, v16
    v_mul_f32 v42, 0x3d800000, v42
    v_cvt_pk_bf16_f32 v16, v43, v43
    v_lshlrev_b32 v43, 16, v16
    v_mul_f32 v43, 0x3d800000, v43
    v_mov_b32 v16, 0xf149f2ca
    v_cndmask_b32 v40, v16, v40, vcc
    v_cndmask_b32 v41, v16, v41, vcc
    v_cndmask_b32 v42, v16, v42, vcc
    v_cndmask_b32 v43, v16, v43, vcc
    v_max3_f32 v17, v32, v33, v34
    v_max_f32 v17, v17, v35
    v_max_f32 v17, v17, v36
    v_max_f32 v17, v17, v37
    v_max_f32 v17, v17, v38
    v_max_f32 v17, v17, v39
    v_max_f32 v17, v17, v40
    v_max_f32 v17, v17, v41
    v_max_f32 v17, v17, v42
    v_max_f32 v17, v17, v43
    v_xor_b32 v14, 16, v1
    v_lshlrev_b32 v14, 2, v14
    ds_bpermute_b32 v15, v14, v17
    s_waitcnt lgkmcnt(0)
    v_max_f32 v17, v17, v15
    v_xor_b32 v14, 32, v1
    v_lshlrev_b32 v14, 2, v14
    ds_bpermute_b32 v15, v14, v17
    s_waitcnt lgkmcnt(0)
    v_max_f32 v17, v17, v15
    v_mov_b32 v18, 0
    v_mov_b32 v19, 0x3fb8aa3b
    v_sub_f32 v32, v32, v17
    v_mul_f32 v32, v19, v32
    v_exp_f32 v32, v32
    v_sub_f32 v33, v33, v17
    v_mul_f32 v33, v19, v33
    v_exp_f32 v33, v33
    v_sub_f32 v34, v34, v17
    v_mul_f32 v34, v19, v34
    v_exp_f32 v34, v34
    v_sub_f32 v35, v35, v17
    v_mul_f32 v35, v19, v35
    v_exp_f32 v35, v35
    v_sub_f32 v36, v36, v17
    v_mul_f32 v36, v19, v36
    v_exp_f32 v36, v36
    v_sub_f32 v37, v37, v17
    v_mul_f32 v37, v19, v37
    v_exp_f32 v37, v37
    v_sub_f32 v38, v38, v17
    v_mul_f32 v38, v19, v38
    v_exp_f32 v38, v38
    v_sub_f32 v39, v39, v17
    v_mul_f32 v39, v19, v39
    v_exp_f32 v39, v39
    v_sub_f32 v40, v40, v17
    v_mul_f32 v40, v19, v40
    v_exp_f32 v40, v40
    v_sub_f32 v41, v41, v17
    v_mul_f32 v41, v19, v41
    v_exp_f32 v41, v41
    v_sub_f32 v42, v42, v17
    v_mul_f32 v42, v19, v42
    v_exp_f32 v42, v42
    v_sub_f32 v43, v43, v17
    v_mul_f32 v43, v19, v43
    v_exp_f32 v43, v43
    s_nop 0
    v_add_f32 v18, v18, v32
    v_add_f32 v18, v18, v33
    v_add_f32 v18, v18, v34
    v_add_f32 v18, v18, v35
    v_add_f32 v18, v18, v36
    v_add_f32 v18, v18, v37
    v_add_f32 v18, v18, v38
    v_add_f32 v18, v18, v39
    v_add_f32 v18, v18, v40
    v_add_f32 v18, v18, v41
    v_add_f32 v18, v18, v42
    v_add_f32 v18, v18, v43
    v_xor_b32 v14, 16, v1
    v_lshlrev_b32 v14, 2, v14
    ds_bpermute_b32 v15, v14, v18
    s_waitcnt lgkmcnt(0)
    v_add_f32 v18, v18, v15
    v_xor_b32 v14, 32, v1
    v_lshlrev_b32 v14, 2, v14
    ds_bpermute_b32 v15, v14, v18
    s_waitcnt lgkmcnt(0)
    v_add_f32 v18, v18, v15
    v_rcp_f32 v18, v18
    s_nop 0
    v_mul_f32 v32, v18, v32
    v_mul_f32 v33, v18, v33
    v_mul_f32 v34, v18, v34
    v_mul_f32 v35, v18, v35
    v_mul_f32 v36, v18, v36
    v_mul_f32 v37, v18, v37
    v_mul_f32 v38, v18, v38
    v_mul_f32 v39, v18, v39
    v_mul_f32 v40, v18, v40
    v_mul_f32 v41, v18, v41
    v_mul_f32 v42, v18, v42
    v_mul_f32 v43, v18, v43
    v_cvt_pk_bf16_f32 v44, v32, v33
    v_cvt_pk_bf16_f32 v45, v34, v35
    v_cvt_pk_bf16_f32 v46, v36, v37
    v_cvt_pk_bf16_f32 v47, v38, v39
    v_cvt_pk_bf16_f32 v48, v40, v41
    v_cvt_pk_bf16_f32 v49, v42, v43
    v_mov_b32 v50, 0
    v_mov_b32 v51, 0
    v_and_b32 v6, 3, v11
    v_lshrrev_b32 v7, 2, v11
    v_lshl_add_u32 v7, v12, 2, v7
    v_mul_u32_u24 v7, 576, v7
    v_lshl_add_u32 v7, v6, 3, v7
    s_lshl_b32 s61, s60, 7
    v_add_u32 v7, s61, v7
    v_add_u32 v7, 65280, v7
    v_mov_b32 v52, 0
    v_mov_b32 v53, 0
    v_mov_b32 v54, 0
    v_mov_b32 v55, 0
    v_mov_b32 v56, 0
    v_mov_b32 v57, 0
    v_mov_b32 v58, 0
    v_mov_b32 v59, 0
    v_mov_b32 v60, 0
    v_mov_b32 v61, 0
    v_mov_b32 v62, 0
    v_mov_b32 v63, 0
    v_mov_b32 v64, 0
    v_mov_b32 v65, 0
    v_mov_b32 v66, 0
    v_mov_b32 v67, 0
    ds_read_b64_tr_b16 v[16:17], v7 offset:0
    ds_read_b64_tr_b16 v[18:19], v7 offset:9216
    s_waitcnt lgkmcnt(0)
    v_mfma_f32_16x16x32_bf16 v[52:55], v[16:19], v[44:47], v[52:55]
    ds_read_b64_tr_b16 v[16:17], v7 offset:32
    ds_read_b64_tr_b16 v[18:19], v7 offset:9248
    s_waitcnt lgkmcnt(0)
    v_mfma_f32_16x16x32_bf16 v[56:59], v[16:19], v[44:47], v[56:59]
    ds_read_b64_tr_b16 v[16:17], v7 offset:64
    ds_read_b64_tr_b16 v[18:19], v7 offset:9280
    s_waitcnt lgkmcnt(0)
    v_mfma_f32_16x16x32_bf16 v[60:63], v[16:19], v[44:47], v[60:63]
    ds_read_b64_tr_b16 v[16:17], v7 offset:96
    ds_read_b64_tr_b16 v[18:19], v7 offset:9312
    s_waitcnt lgkmcnt(0)
    v_mfma_f32_16x16x32_bf16 v[64:67], v[16:19], v[44:47], v[64:67]
    ds_read_b64_tr_b16 v[16:17], v7 offset:18432
    ds_read_b64_tr_b16 v[18:19], v7 offset:27648
    s_waitcnt lgkmcnt(0)
    v_mfma_f32_16x16x32_bf16 v[52:55], v[16:19], v[48:51], v[52:55]
    ds_read_b64_tr_b16 v[16:17], v7 offset:18464
    ds_read_b64_tr_b16 v[18:19], v7 offset:27680
    s_waitcnt lgkmcnt(0)
    v_mfma_f32_16x16x32_bf16 v[56:59], v[16:19], v[48:51], v[56:59]
    ds_read_b64_tr_b16 v[16:17], v7 offset:18496
    ds_read_b64_tr_b16 v[18:19], v7 offset:27712
    s_waitcnt lgkmcnt(0)
    v_mfma_f32_16x16x32_bf16 v[60:63], v[16:19], v[48:51], v[60:63]
    ds_read_b64_tr_b16 v[16:17], v7 offset:18528
    ds_read_b64_tr_b16 v[18:19], v7 offset:27744
    s_waitcnt lgkmcnt(0)
    v_mfma_f32_16x16x32_bf16 v[64:67], v[16:19], v[48:51], v[64:67]
    s_nop 7
    s_nop 7
    v_mul_u32_u24 v5, 528, v11
    v_lshl_add_u32 v5, v12, 3, v5
    v_add_u32 v5, s61, v5
    v_cvt_pk_bf16_f32 v16, v52, v53
    v_cvt_pk_bf16_f32 v17, v54, v55
    ds_write_b64 v5, v[16:17] offset:0
    s_nop 0
    v_cvt_pk_bf16_f32 v16, v56, v57
    v_cvt_pk_bf16_f32 v17, v58, v59
    ds_write_b64 v5, v[16:17] offset:32
    s_nop 0
    v_cvt_pk_bf16_f32 v16, v60, v61
    v_cvt_pk_bf16_f32 v17, v62, v63
    ds_write_b64 v5, v[16:17] offset:64
    s_nop 0
    v_cvt_pk_bf16_f32 v16, v64, v65
    v_cvt_pk_bf16_f32 v17, v66, v67
    ds_write_b64 v5, v[16:17] offset:96
    s_nop 0
    s_waitcnt lgkmcnt(0)
    s_barrier
    v_mul_u32_u24 v5, 528, v11
    v_lshl_add_u32 v5, v12, 4, v5
    v_mov_b32 v32, 0
    v_mov_b32 v33, 0
    v_mov_b32 v34, 0
    v_mov_b32 v35, 0
    v_mov_b32 v36, 0
    v_mov_b32 v37, 0
    v_mov_b32 v38, 0
    v_mov_b32 v39, 0
    ds_read_b128 v[16:19], v5 offset:0
    s_waitcnt lgkmcnt(0)
    v_mfma_f32_16x16x32_bf16 v[32:35], a[168:171], v[16:19], v[32:35]
    v_mfma_f32_16x16x32_bf16 v[36:39], a[200:203], v[16:19], v[36:39]
    ds_read_b128 v[16:19], v5 offset:64
    s_waitcnt lgkmcnt(0)
    v_mfma_f32_16x16x32_bf16 v[32:35], a[172:175], v[16:19], v[32:35]
    v_mfma_f32_16x16x32_bf16 v[36:39], a[204:207], v[16:19], v[36:39]
    ds_read_b128 v[16:19], v5 offset:128
    s_waitcnt lgkmcnt(0)
    v_mfma_f32_16x16x32_bf16 v[32:35], a[176:179], v[16:19], v[32:35]
    v_mfma_f32_16x16x32_bf16 v[36:39], a[208:211], v[16:19], v[36:39]
    ds_read_b128 v[16:19], v5 offset:192
    s_waitcnt lgkmcnt(0)
    v_mfma_f32_16x16x32_bf16 v[32:35], a[180:183], v[16:19], v[32:35]
    v_mfma_f32_16x16x32_bf16 v[36:39], a[212:215], v[16:19], v[36:39]
    ds_read_b128 v[16:19], v5 offset:256
    s_waitcnt lgkmcnt(0)
    v_mfma_f32_16x16x32_bf16 v[32:35], a[184:187], v[16:19], v[32:35]
    v_mfma_f32_16x16x32_bf16 v[36:39], a[216:219], v[16:19], v[36:39]
    ds_read_b128 v[16:19], v5 offset:320
    s_waitcnt lgkmcnt(0)
    v_mfma_f32_16x16x32_bf16 v[32:35], a[188:191], v[16:19], v[32:35]
    v_mfma_f32_16x16x32_bf16 v[36:39], a[220:223], v[16:19], v[36:39]
    ds_read_b128 v[16:19], v5 offset:384
    s_waitcnt lgkmcnt(0)
    v_mfma_f32_16x16x32_bf16 v[32:35], a[192:195], v[16:19], v[32:35]
    v_mfma_f32_16x16x32_bf16 v[36:39], a[224:227], v[16:19], v[36:39]
    ds_read_b128 v[16:19], v5 offset:448
    s_waitcnt lgkmcnt(0)
    v_mfma_f32_16x16x32_bf16 v[32:35], a[196:199], v[16:19], v[32:35]
    v_mfma_f32_16x16x32_bf16 v[36:39], a[228:231], v[16:19], v[36:39]
    s_nop 7
    s_nop 7
    s_add_u32 s61, s68, 1
    s_mul_i32 s61, s61, 14336
    s_add_u32 s61, s61, 146800640
    s_mul_i32 s62, s67, 448
    s_add_u32 s61, s61, s62
    v_mul_u32_u24 v6, 1792, v11
    v_lshl_add_u32 v6, v12, 4, v6
    v_add_u32 v6, s61, v6
    v_cmp_gt_u32 vcc, 8, v11
    s_and_saveexec_b64 s[70:71], vcc
    s_add_u32 s62, s60, 0
    s_cmp_gt_u32 s62, 6
    s_cbranch_scc1 cska_26
    s_lshl_b32 s62, s62, 6
    v_add_u32 v7, s62, v6
    global_atomic_add_f32 v7, v32, s[46:47] offset:0
    global_atomic_add_f32 v7, v33, s[46:47] offset:4
    global_atomic_add_f32 v7, v34, s[46:47] offset:8
    global_atomic_add_f32 v7, v35, s[46:47] offset:12
cska_26:
    s_add_u32 s62, s60, 4
    s_cmp_gt_u32 s62, 6
    s_cbranch_scc1 cska_27
    s_lshl_b32 s62, s62, 6
    v_add_u32 v7, s62, v6
    global_atomic_add_f32 v7, v36, s[46:47] offset:0
    global_atomic_add_f32 v7, v37, s[46:47] offset:4
    global_atomic_add_f32 v7, v38, s[46:47] offset:8
    global_atomic_add_f32 v7, v39, s[46:47] offset:12
cska_27:
    s_mov_b64 exec, s[70:71]
    s_waitcnt vmcnt(0)
    s_barrier
    v_cmp_eq_u32 vcc, 0, v0
    s_and_saveexec_b64 s[70:71], vcc
    s_cbranch_execz post_28
    s_add_u32 s61, s68, 1
    v_mov_b32 v15, s61
    s_lshl_b32 s62, s2, 2
    v_mov_b32 v14, s62
    v_add_u32 v14, 147734784, v14
    global_store_dword v14, v15, s[46:47] sc1
post_28:
    s_mov_b64 exec, s[70:71]
    s_add_u32 s68, s68, 1
    s_cmp_lt_u32 s68, 64
    s_cbranch_scc1 cloop_17
cdone_16:
    s_endpgm
.globl attna_kernel
.p2align 8
.type attna_kernel,@function
attna_kernel:
    s_cmp_ge_u32 s2, 512
    s_cbranch_scc1 aadone_29
    s_load_dwordx16 s[16:31], s[0:1], 0
    s_load_dwordx16 s[32:47], s[0:1], 64
    s_lshr_b32 s61, s2, 3
    s_and_b32 s60, s2, 7
    v_and_b32 v1, 63, v0
    v_lshrrev_b32 v2, 6, v0
    v_and_b32 v3, 31, v1
    v_lshrrev_b32 v4, 5, v1
    v_lshl_add_u32 v7, s60, 1, v2
    v_mul_u32_u24 v29, 70656, v2
    s_waitcnt lgkmcnt(0)
    v_mov_b32 v64, 0
    v_mov_b32 v65, 0
    v_mov_b32 v66, 0
    v_mov_b32 v67, 0
    v_lshl_add_u32 v6, v1, 4, v29
    ds_write_b128 v6, v[64:67]
    v_add_u32 v6, 1024, v6
    ds_write_b128 v6, v[64:67]
    v_add_u32 v6, 1024, v6
    ds_write_b128 v6, v[64:67]
    v_add_u32 v6, 1024, v6
    ds_write_b128 v6, v[64:67]
    v_add_u32 v6, 1024, v6
    ds_write_b128 v6, v[64:67]
    v_add_u32 v6, 1024, v6
    ds_write_b128 v6, v[64:67]
    v_add_u32 v6, 1024, v6
    ds_write_b128 v6, v[64:67]
    v_add_u32 v6, 1024, v6
    ds_write_b128 v6, v[64:67]
    v_add_u32 v6, 1024, v6
    ds_write_b128 v6, v[64:67]
    v_add_u32 v6, 1024, v6
    ds_write_b128 v6, v[64:67]
    v_add_u32 v6, 1024, v6
    ds_write_b128 v6, v[64:67]
    v_add_u32 v6, 1024, v6
    ds_write_b128 v6, v[64:67]
    v_add_u32 v6, 1024, v6
    ds_write_b128 v6, v[64:67]
    v_add_u32 v6, 1024, v6
    ds_write_b128 v6, v[64:67]
    v_add_u32 v6, 1024, v6
    ds_write_b128 v6, v[64:67]
    v_add_u32 v6, 1024, v6
    ds_write_b128 v6, v[64:67]
    v_add_u32 v6, 1024, v6
    ds_write_b128 v6, v[64:67]
    v_add_u32 v6, 1024, v6
    ds_write_b128 v6, v[64:67]
    v_add_u32 v6, 1024, v6
    ds_write_b128 v6, v[64:67]
    v_add_u32 v6, 1024, v6
    ds_write_b128 v6, v[64:67]
    v_add_u32 v6, 1024, v6
    ds_write_b128 v6, v[64:67]
    v_add_u32 v6, 1024, v6
    ds_write_b128 v6, v[64:67]
    v_add_u32 v6, 1024, v6
    ds_write_b128 v6, v[64:67]
    v_add_u32 v6, 1024, v6
    ds_write_b128 v6, v[64:67]
    v_add_u32 v6, 1024, v6
    ds_write_b128 v6, v[64:67]
    v_add_u32 v6, 1024, v6
    ds_write_b128 v6, v[64:67]
    v_add_u32 v6, 1024, v6
    ds_write_b128 v6, v[64:67]
    v_add_u32 v6, 1024, v6
    ds_write_b128 v6, v[64:67]
    v_add_u32 v6, 1024, v6
    ds_write_b128 v6, v[64:67]
    v_add_u32 v6, 1024, v6
    ds_write_b128 v6, v[64:67]
    v_add_u32 v6, 1024, v6
    ds_write_b128 v6, v[64:67]
    v_add_u32 v6, 1024, v6
    ds_write_b128 v6, v[64:67]
    v_add_u32 v6, 1024, v6
    ds_write_b128 v6, v[64:67]
    v_add_u32 v6, 1024, v6
    ds_write_b128 v6, v[64:67]
    v_add_u32 v6, 1024, v6
    ds_write_b128 v6, v[64:67]
    v_add_u32 v6, 1024, v6
    ds_write_b128 v6, v[64:67]
    v_add_u32 v6, 1024, v6
    ds_write_b128 v6, v[64:67]
    v_add_u32 v6, 1024, v6
    ds_write_b128 v6, v[64:67]
    v_add_u32 v6, 1024, v6
    ds_write_b128 v6, v[64:67]
    v_add_u32 v6, 1024, v6
    ds_write_b128 v6, v[64:67]
    v_add_u32 v6, 1024, v6
    ds_write_b128 v6, v[64:67]
    v_add_u32 v6, 1024, v6
    ds_write_b128 v6, v[64:67]
    v_add_u32 v6, 1024, v6
    ds_write_b128 v6, v[64:67]
    v_add_u32 v6, 1024, v6
    ds_write_b128 v6, v[64:67]
    v_add_u32 v6, 1024, v6
    ds_write_b128 v6, v[64:67]
    v_add_u32 v6, 1024, v6
    ds_write_b128 v6, v[64:67]
    v_add_u32 v6, 1024, v6
    ds_write_b128 v6, v[64:67]
    v_add_u32 v6, 1024, v6
    ds_write_b128 v6, v[64:67]
    v_add_u32 v6, 1024, v6
    ds_write_b128 v6, v[64:67]
    v_add_u32 v6, 1024, v6
    ds_write_b128 v6, v[64:67]
    v_add_u32 v6, 1024, v6
    ds_write_b128 v6, v[64:67]
    v_add_u32 v6, 1024, v6
    ds_write_b128 v6, v[64:67]
    v_add_u32 v6, 1024, v6
    ds_write_b128 v6, v[64:67]
    v_add_u32 v6, 1024, v6
    ds_write_b128 v6, v[64:67]
    v_add_u32 v6, 1024, v6
    ds_write_b128 v6, v[64:67]
    v_add_u32 v6, 1024, v6
    ds_write_b128 v6, v[64:67]
    v_add_u32 v6, 1024, v6
    ds_write_b128 v6, v[64:67]
    v_add_u32 v6, 1024, v6
    ds_write_b128 v6, v[64:67]
    v_add_u32 v6, 1024, v6
    ds_write_b128 v6, v[64:67]
    v_add_u32 v6, 1024, v6
    ds_write_b128 v6, v[64:67]
    v_add_u32 v6, 1024, v6
    ds_write_b128 v6, v[64:67]
    v_add_u32 v6, 1024, v6
    ds_write_b128 v6, v[64:67]
    v_add_u32 v6, 1024, v6
    ds_write_b128 v6, v[64:67]
    v_add_u32 v6, 1024, v6
    ds_write_b128 v6, v[64:67]
    v_add_u32 v6, 1024, v6
    ds_write_b128 v6, v[64:67]
    v_add_u32 v6, 1024, v6
    ds_write_b128 v6, v[64:67]
    v_add_u32 v6, 1024, v6
    ds_write_b128 v6, v[64:67]
    v_add_u32 v6, 1024, v6
    ds_write_b128 v6, v[64:67]
    v_add_u32 v6, 1024, v6
    ds_write_b128 v6, v[64:67]
    v_add_u32 v6, 1024, v6
    s_lshl_b32 s62, s61, 5
    v_add_u32 v5, s62, v3
    v_mul_u32_u24 v6, 24576, v5
    v_lshl_add_u32 v6, v4, 4, v6
    v_lshl_add_u32 v6, v7, 9, v6
    global_load_dwordx4 v[64:67], v6, s[46:47] offset:0
    global_load_dwordx4 v[68:71], v6, s[46:47] offset:32
    global_load_dwordx4 v[72:75], v6, s[46:47] offset:64
    global_load_dwordx4 v[76:79], v6, s[46:47] offset:96
    global_load_dwordx4 v[80:83], v6, s[46:47] offset:128
    global_load_dwordx4 v[84:87], v6, s[46:47] offset:160
    global_load_dwordx4 v[88:91], v6, s[46:47] offset:192
    global_load_dwordx4 v[92:95], v6, s[46:47] offset:224
    global_load_dwordx4 v[96:99], v6, s[46:47] offset:256
    global_load_dwordx4 v[100:103], v6, s[46:47] offset:288
    global_load_dwordx4 v[104:107], v6, s[46:47] offset:320
    global_load_dwordx4 v[108:111], v6, s[46:47] offset:352
    global_load_dwordx4 v[112:115], v6, s[46:47] offset:384
    global_load_dwordx4 v[116:119], v6, s[46:47] offset:416
    global_load_dwordx4 v[120:123], v6, s[46:47] offset:448
    global_load_dwordx4 v[124:127], v6, s[46:47] offset:480
    s_waitcnt vmcnt(0)
    v_accvgpr_write_b32 a0, v64
    v_accvgpr_write_b32 a1, v65
    v_accvgpr_write_b32 a2, v66
    v_accvgpr_write_b32 a3, v67
    v_accvgpr_write_b32 a4, v68
    v_accvgpr_write_b32 a5, v69
    v_accvgpr_write_b32 a6, v70
    v_accvgpr_write_b32 a7, v71
    v_accvgpr_write_b32 a8, v72
    v_accvgpr_write_b32 a9, v73
    v_accvgpr_write_b32 a10, v74
    v_accvgpr_write_b32 a11, v75
    v_accvgpr_write_b32 a12, v76
    v_accvgpr_write_b32 a13, v77
    v_accvgpr_write_b32 a14, v78
    v_accvgpr_write_b32 a15, v79
    v_accvgpr_write_b32 a16, v80
    v_accvgpr_write_b32 a17, v81
    v_accvgpr_write_b32 a18, v82
    v_accvgpr_write_b32 a19, v83
    v_accvgpr_write_b32 a20, v84
    v_accvgpr_write_b32 a21, v85
    v_accvgpr_write_b32 a22, v86
    v_accvgpr_write_b32 a23, v87
    v_accvgpr_write_b32 a24, v88
    v_accvgpr_write_b32 a25, v89
    v_accvgpr_write_b32 a26, v90
    v_accvgpr_write_b32 a27, v91
    v_accvgpr_write_b32 a28, v92
    v_accvgpr_write_b32 a29, v93
    v_accvgpr_write_b32 a30, v94
    v_accvgpr_write_b32 a31, v95
    v_accvgpr_write_b32 a32, v96
    v_accvgpr_write_b32 a33, v97
    v_accvgpr_write_b32 a34, v98
    v_accvgpr_write_b32 a35, v99
    v_accvgpr_write_b32 a36, v100
    v_accvgpr_write_b32 a37, v101
    v_accvgpr_write_b32 a38, v102
    v_accvgpr_write_b32 a39, v103
    v_accvgpr_write_b32 a40, v104
    v_accvgpr_write_b32 a41, v105
    v_accvgpr_write_b32 a42, v106
    v_accvgpr_write_b32 a43, v107
    v_accvgpr_write_b32 a44, v108
    v_accvgpr_write_b32 a45, v109
    v_accvgpr_write_b32 a46, v110
    v_accvgpr_write_b32 a47, v111
    v_accvgpr_write_b32 a48, v112
    v_accvgpr_write_b32 a49, v113
    v_accvgpr_write_b32 a50, v114
    v_accvgpr_write_b32 a51, v115
    v_accvgpr_write_b32 a52, v116
    v_accvgpr_write_b32 a53, v117
    v_accvgpr_write_b32 a54, v118
    v_accvgpr_write_b32 a55, v119
    v_accvgpr_write_b32 a56, v120
    v_accvgpr_write_b32 a57, v121
    v_accvgpr_write_b32 a58, v122
    v_accvgpr_write_b32 a59, v123
    v_accvgpr_write_b32 a60, v124
    v_accvgpr_write_b32 a61, v125
    v_accvgpr_write_b32 a62, v126
    v_accvgpr_write_b32 a63, v127
    v_lshrrev_b32 v10, 5, v1
    v_add_u32 v12, s62, v10
    v_mul_u32_u24 v12, 24576, v12
    v_lshl_add_u32 v12, v3, 4, v12
    v_lshl_add_u32 v12, v7, 9, v12
    v_mul_u32_u24 v13, 528, v10
    v_lshl_add_u32 v13, v3, 4, v13
    v_add_u32 v13, v13, v29
    v_mul_u32_u24 v14, 576, v10
    v_lshl_add_u32 v14, v3, 4, v14
    v_add_u32 v14, v14, v29
    v_add_u32 v14, 33792, v14
    s_waitcnt lgkmcnt(0)
    global_load_dwordx4 v[64:67], v12, s[46:47] offset:0
    v_add_u32 v11, 8192, v12
    global_load_dwordx4 v[68:71], v11, s[46:47] offset:0
    v_add_u32 v11, 8192, v11
    global_load_dwordx4 v[72:75], v11, s[46:47] offset:0
    v_add_u32 v12, 49152, v12
    s_waitcnt vmcnt(0)
    ds_write_b128 v13, v[68:71] offset:4224
    ds_write_b128 v14, v[72:75] offset:4608
    global_load_dwordx4 v[64:67], v12, s[46:47] offset:0
    v_add_u32 v11, 8192, v12
    global_load_dwordx4 v[68:71], v11, s[46:47] offset:0
    v_add_u32 v11, 8192, v11
    global_load_dwordx4 v[72:75], v11, s[46:47] offset:0
    v_add_u32 v12, 49152, v12
    s_waitcnt vmcnt(0)
    ds_write_b128 v13, v[68:71] offset:5280
    ds_write_b128 v14, v[72:75] offset:5760
    global_load_dwordx4 v[64:67], v12, s[46:47] offset:0
    v_add_u32 v11, 8192, v12
    global_load_dwordx4 v[68:71], v11, s[46:47] offset:0
    v_add_u32 v11, 8192, v11
    global_load_dwordx4 v[72:75], v11, s[46:47] offset:0
    v_add_u32 v12, 49152, v12
    s_waitcnt vmcnt(0)
    ds_write_b128 v13, v[68:71] offset:6336
    ds_write_b128 v14, v[72:75] offset:6912
    global_load_dwordx4 v[64:67], v12, s[46:47] offset:0
    v_add_u32 v11, 8192, v12
    global_load_dwordx4 v[68:71], v11, s[46:47] offset:0
    v_add_u32 v11, 8192, v11
    global_load_dwordx4 v[72:75], v11, s[46:47] offset:0
    v_add_u32 v12, 49152, v12
    s_waitcnt vmcnt(0)
    ds_write_b128 v13, v[68:71] offset:7392
    ds_write_b128 v14, v[72:75] offset:8064
    global_load_dwordx4 v[64:67], v12, s[46:47] offset:0
    v_add_u32 v11, 8192, v12
    global_load_dwordx4 v[68:71], v11, s[46:47] offset:0
    v_add_u32 v11, 8192, v11
    global_load_dwordx4 v[72:75], v11, s[46:47] offset:0
    v_add_u32 v12, 49152, v12
    s_waitcnt vmcnt(0)
    ds_write_b128 v13, v[68:71] offset:8448
    ds_write_b128 v14, v[72:75] offset:9216
    global_load_dwordx4 v[64:67], v12, s[46:47] offset:0
    v_add_u32 v11, 8192, v12
    global_load_dwordx4 v[68:71], v11, s[46:47] offset:0
    v_add_u32 v11, 8192, v11
    global_load_dwordx4 v[72:75], v11, s[46:47] offset:0
    v_add_u32 v12, 49152, v12
    s_waitcnt vmcnt(0)
    ds_write_b128 v13, v[68:71] offset:9504
    ds_write_b128 v14, v[72:75] offset:10368
    global_load_dwordx4 v[64:67], v12, s[46:47] offset:0
    v_add_u32 v11, 8192, v12
    global_load_dwordx4 v[68:71], v11, s[46:47] offset:0
    v_add_u32 v11, 8192, v11
    global_load_dwordx4 v[72:75], v11, s[46:47] offset:0
    v_add_u32 v12, 49152, v12
    s_waitcnt vmcnt(0)
    ds_write_b128 v13, v[68:71] offset:10560
    ds_write_b128 v14, v[72:75] offset:11520
    global_load_dwordx4 v[64:67], v12, s[46:47] offset:0
    v_add_u32 v11, 8192, v12
    global_load_dwordx4 v[68:71], v11, s[46:47] offset:0
    v_add_u32 v11, 8192, v11
    global_load_dwordx4 v[72:75], v11, s[46:47] offset:0
    v_add_u32 v12, 49152, v12
    s_waitcnt vmcnt(0)
    ds_write_b128 v13, v[68:71] offset:11616
    ds_write_b128 v14, v[72:75] offset:12672
    global_load_dwordx4 v[64:67], v12, s[46:47] offset:0
    v_add_u32 v11, 8192, v12
    global_load_dwordx4 v[68:71], v11, s[46:47] offset:0
    v_add_u32 v11, 8192, v11
    global_load_dwordx4 v[72:75], v11, s[46:47] offset:0
    v_add_u32 v12, 49152, v12
    s_waitcnt vmcnt(0)
    ds_write_b128 v13, v[68:71] offset:12672
    ds_write_b128 v14, v[72:75] offset:13824
    global_load_dwordx4 v[64:67], v12, s[46:47] offset:0
    v_add_u32 v11, 8192, v12
    global_load_dwordx4 v[68:71], v11, s[46:47] offset:0
    v_add_u32 v11, 8192, v11
    global_load_dwordx4 v[72:75], v11, s[46:47] offset:0
    v_add_u32 v12, 49152, v12
    s_waitcnt vmcnt(0)
    ds_write_b128 v13, v[68:71] offset:13728
    ds_write_b128 v14, v[72:75] offset:14976
    global_load_dwordx4 v[64:67], v12, s[46:47] offset:0
    v_add_u32 v11, 8192, v12
    global_load_dwordx4 v[68:71], v11, s[46:47] offset:0
    v_add_u32 v11, 8192, v11
    global_load_dwordx4 v[72:75], v11, s[46:47] offset:0
    v_add_u32 v12, 49152, v12
    s_waitcnt vmcnt(0)
    ds_write_b128 v13, v[68:71] offset:14784
    ds_write_b128 v14, v[72:75] offset:16128
    global_load_dwordx4 v[64:67], v12, s[46:47] offset:0
    v_add_u32 v11, 8192, v12
    global_load_dwordx4 v[68:71], v11, s[46:47] offset:0
    v_add_u32 v11, 8192, v11
    global_load_dwordx4 v[72:75], v11, s[46:47] offset:0
    v_add_u32 v12, 49152, v12
    s_waitcnt vmcnt(0)
    ds_write_b128 v13, v[68:71] offset:15840
    ds_write_b128 v14, v[72:75] offset:17280
    global_load_dwordx4 v[64:67], v12, s[46:47] offset:0
    v_add_u32 v11, 8192, v12
    global_load_dwordx4 v[68:71], v11, s[46:47] offset:0
    v_add_u32 v11, 8192, v11
    global_load_dwordx4 v[72:75], v11, s[46:47] offset:0
    v_add_u32 v12, 49152, v12
    s_waitcnt vmcnt(0)
    ds_write_b128 v13, v[68:71] offset:16896
    ds_write_b128 v14, v[72:75] offset:18432
    global_load_dwordx4 v[64:67], v12, s[46:47] offset:0
    v_add_u32 v11, 8192, v12
    global_load_dwordx4 v[68:71], v11, s[46:47] offset:0
    v_add_u32 v11, 8192, v11
    global_load_dwordx4 v[72:75], v11, s[46:47] offset:0
    v_add_u32 v12, 49152, v12
    s_waitcnt vmcnt(0)
    ds_write_b128 v13, v[68:71] offset:17952
    ds_write_b128 v14, v[72:75] offset:19584
    global_load_dwordx4 v[64:67], v12, s[46:47] offset:0
    v_add_u32 v11, 8192, v12
    global_load_dwordx4 v[68:71], v11, s[46:47] offset:0
    v_add_u32 v11, 8192, v11
    global_load_dwordx4 v[72:75], v11, s[46:47] offset:0
    v_add_u32 v12, 49152, v12
    s_waitcnt vmcnt(0)
    ds_write_b128 v13, v[68:71] offset:19008
    ds_write_b128 v14, v[72:75] offset:20736
    global_load_dwordx4 v[64:67], v12, s[46:47] offset:0
    v_add_u32 v11, 8192, v12
    global_load_dwordx4 v[68:71], v11, s[46:47] offset:0
    v_add_u32 v11, 8192, v11
    global_load_dwordx4 v[72:75], v11, s[46:47] offset:0
    v_add_u32 v12, 49152, v12
    s_waitcnt vmcnt(0)
    ds_write_b128 v13, v[68:71] offset:20064
    ds_write_b128 v14, v[72:75] offset:21888
    s_mul_i32 s63, s61, 196608
    s_add_u32 s63, s63, 134225920
    v_mul_u32_u24 v12, 24576, v10
    v_lshl_add_u32 v12, v3, 4, v12
    v_lshl_add_u32 v12, v7, 9, v12
    v_add_u32 v12, s63, v12
    global_load_dwordx4 v[68:71], v12, s[46:47] offset:0
    v_add_u32 v11, 8192, v12
    global_load_dwordx4 v[72:75], v11, s[46:47] offset:0
    v_add_u32 v12, 49152, v12
    s_waitcnt vmcnt(0)
    ds_write_b128 v13, v[68:71] offset:0
    ds_write_b128 v14, v[72:75] offset:0
    global_load_dwordx4 v[68:71], v12, s[46:47] offset:0
    v_add_u32 v11, 8192, v12
    global_load_dwordx4 v[72:75], v11, s[46:47] offset:0
    v_add_u32 v12, 49152, v12
    s_waitcnt vmcnt(0)
    ds_write_b128 v13, v[68:71] offset:1056
    ds_write_b128 v14, v[72:75] offset:1152
    global_load_dwordx4 v[68:71], v12, s[46:47] offset:0
    v_add_u32 v11, 8192, v12
    global_load_dwordx4 v[72:75], v11, s[46:47] offset:0
    v_add_u32 v12, 49152, v12
    s_waitcnt vmcnt(0)
    ds_write_b128 v13, v[68:71] offset:2112
    ds_write_b128 v14, v[72:75] offset:2304
    global_load_dwordx4 v[68:71], v12, s[46:47] offset:0
    v_add_u32 v11, 8192, v12
    global_load_dwordx4 v[72:75], v11, s[46:47] offset:0
    v_add_u32 v12, 49152, v12
    s_waitcnt vmcnt(0)
    ds_write_b128 v13, v[68:71] offset:3168
    ds_write_b128 v14, v[72:75] offset:3456
    s_waitcnt lgkmcnt(0)
    v_mul_u32_u24 v15, 528, v3
    v_lshl_add_u32 v15, v4, 4, v15
    v_add_u32 v15, v15, v29
    v_and_b32 v16, 15, v1
    v_lshrrev_b32 v17, 2, v16
    v_lshl_add_u32 v17, v4, 2, v17
    v_mul_u32_u24 v17, 576, v17
    v_and_b32 v16, 3, v16
    v_lshl_add_u32 v17, v16, 3, v17
    v_bfe_u32 v16, v1, 4, 1
    v_lshl_add_u32 v17, v16, 5, v17
    v_add_u32 v17, 33792, v17
    v_add_u32 v17, v17, v29
    v_mov_b32 v32, 0
    v_mov_b32 v33, 0
    v_mov_b32 v34, 0
    v_mov_b32 v35, 0
    v_mov_b32 v36, 0
    v_mov_b32 v37, 0
    v_mov_b32 v38, 0
    v_mov_b32 v39, 0
    v_mov_b32 v40, 0
    v_mov_b32 v41, 0
    v_mov_b32 v42, 0
    v_mov_b32 v43, 0
    v_mov_b32 v44, 0
    v_mov_b32 v45, 0
    v_mov_b32 v46, 0
    v_mov_b32 v47, 0
    v_mov_b32 v48, 0
    v_mov_b32 v49, 0
    v_mov_b32 v50, 0
    v_mov_b32 v51, 0
    v_mov_b32 v52, 0
    v_mov_b32 v53, 0
    v_mov_b32 v54, 0
    v_mov_b32 v55, 0
    v_mov_b32 v56, 0
    v_mov_b32 v57, 0
    v_mov_b32 v58, 0
    v_mov_b32 v59, 0
    v_mov_b32 v60, 0
    v_mov_b32 v61, 0
    v_mov_b32 v62, 0
    v_mov_b32 v63, 0
    v_mov_b32 v128, 0
    v_mov_b32 v129, 0
    v_mov_b32 v130, 0
    v_mov_b32 v131, 0
    v_mov_b32 v132, 0
    v_mov_b32 v133, 0
    v_mov_b32 v134, 0
    v_mov_b32 v135, 0
    v_mov_b32 v136, 0
    v_mov_b32 v137, 0
    v_mov_b32 v138, 0
    v_mov_b32 v139, 0
    v_mov_b32 v140, 0
    v_mov_b32 v141, 0
    v_mov_b32 v142, 0
    v_mov_b32 v143, 0
    v_mov_b32 v144, 0
    v_mov_b32 v145, 0
    v_mov_b32 v146, 0
    v_mov_b32 v147, 0
    v_mov_b32 v148, 0
    v_mov_b32 v149, 0
    v_mov_b32 v150, 0
    v_mov_b32 v151, 0
    v_mov_b32 v152, 0
    v_mov_b32 v153, 0
    v_mov_b32 v154, 0
    v_mov_b32 v155, 0
    v_mov_b32 v156, 0
    v_mov_b32 v157, 0
    v_mov_b32 v158, 0
    v_mov_b32 v159, 0
    v_mov_b32 v160, 0
    v_mov_b32 v161, 0
    v_mov_b32 v162, 0
    v_mov_b32 v163, 0
    v_mov_b32 v164, 0
    v_mov_b32 v165, 0
    v_mov_b32 v166, 0
    v_mov_b32 v167, 0
    v_mov_b32 v168, 0
    v_mov_b32 v169, 0
    v_mov_b32 v170, 0
    v_mov_b32 v171, 0
    v_mov_b32 v172, 0
    v_mov_b32 v173, 0
    v_mov_b32 v174, 0
    v_mov_b32 v175, 0
    v_mov_b32 v176, 0
    v_mov_b32 v177, 0
    v_mov_b32 v178, 0
    v_mov_b32 v179, 0
    v_mov_b32 v180, 0
    v_mov_b32 v181, 0
    v_mov_b32 v182, 0
    v_mov_b32 v183, 0
    v_mov_b32 v184, 0
    v_mov_b32 v185, 0
    v_mov_b32 v186, 0
    v_mov_b32 v187, 0
    v_mov_b32 v188, 0
    v_mov_b32 v189, 0
    v_mov_b32 v190, 0
    v_mov_b32 v191, 0
    v_mov_b32 v192, 0
    v_mov_b32 v193, 0
    v_mov_b32 v194, 0
    v_mov_b32 v195, 0
    v_mov_b32 v196, 0
    v_mov_b32 v197, 0
    v_mov_b32 v198, 0
    v_mov_b32 v199, 0
    v_mov_b32 v200, 0
    v_mov_b32 v201, 0
    v_mov_b32 v202, 0
    v_mov_b32 v203, 0
    v_mov_b32 v204, 0
    v_mov_b32 v205, 0
    v_mov_b32 v206, 0
    v_mov_b32 v207, 0
    v_mov_b32 v208, 0
    v_mov_b32 v209, 0
    v_mov_b32 v210, 0
    v_mov_b32 v211, 0
    v_mov_b32 v212, 0
    v_mov_b32 v213, 0
    v_mov_b32 v214, 0
    v_mov_b32 v215, 0
    v_mov_b32 v216, 0
    v_mov_b32 v217, 0
    v_mov_b32 v218, 0
    v_mov_b32 v219, 0
    v_mov_b32 v220, 0
    v_mov_b32 v221, 0
    v_mov_b32 v222, 0
    v_mov_b32 v223, 0
    v_mov_b32 v224, 0
    v_mov_b32 v225, 0
    v_mov_b32 v226, 0
    v_mov_b32 v227, 0
    v_mov_b32 v228, 0
    v_mov_b32 v229, 0
    v_mov_b32 v230, 0
    v_mov_b32 v231, 0
    v_mov_b32 v232, 0
    v_mov_b32 v233, 0
    v_mov_b32 v234, 0
    v_mov_b32 v235, 0
    v_mov_b32 v236, 0
    v_mov_b32 v237, 0
    v_mov_b32 v238, 0
    v_mov_b32 v239, 0
    v_mov_b32 v240, 0
    v_mov_b32 v241, 0
    v_mov_b32 v242, 0
    v_mov_b32 v243, 0
    v_mov_b32 v244, 0
    v_mov_b32 v245, 0
    v_mov_b32 v246, 0
    v_mov_b32 v247, 0
    v_mov_b32 v248, 0
    v_mov_b32 v249, 0
    v_mov_b32 v250, 0
    v_mov_b32 v251, 0
    v_mov_b32 v252, 0
    v_mov_b32 v253, 0
    v_mov_b32 v254, 0
    v_mov_b32 v255, 0
    ds_read_b128 v[20:23], v15 offset:0
    ds_read_b128 v[24:27], v15 offset:16896
    s_waitcnt lgkmcnt(0)
    v_mfma_f32_32x32x16_bf16 v[32:47], v[20:23], a[0:3], v[32:47]
    v_mfma_f32_32x32x16_bf16 v[48:63], v[24:27], a[0:3], v[48:63]
    ds_read_b128 v[20:23], v15 offset:32
    ds_read_b128 v[24:27], v15 offset:16928
    s_waitcnt lgkmcnt(0)
    v_mfma_f32_32x32x16_bf16 v[32:47], v[20:23], a[4:7], v[32:47]
    v_mfma_f32_32x32x16_bf16 v[48:63], v[24:27], a[4:7], v[48:63]
    ds_read_b128 v[20:23], v15 offset:64
    ds_read_b128 v[24:27], v15 offset:16960
    s_waitcnt lgkmcnt(0)
    v_mfma_f32_32x32x16_bf16 v[32:47], v[20:23], a[8:11], v[32:47]
    v_mfma_f32_32x32x16_bf16 v[48:63], v[24:27], a[8:11], v[48:63]
    ds_read_b128 v[20:23], v15 offset:96
    ds_read_b128 v[24:27], v15 offset:16992
    s_waitcnt lgkmcnt(0)
    v_mfma_f32_32x32x16_bf16 v[32:47], v[20:23], a[12:15], v[32:47]
    v_mfma_f32_32x32x16_bf16 v[48:63], v[24:27], a[12:15], v[48:63]
    ds_read_b128 v[20:23], v15 offset:128
    ds_read_b128 v[24:27], v15 offset:17024
    s_waitcnt lgkmcnt(0)
    v_mfma_f32_32x32x16_bf16 v[32:47], v[20:23], a[16:19], v[32:47]
    v_mfma_f32_32x32x16_bf16 v[48:63], v[24:27], a[16:19], v[48:63]
    ds_read_b128 v[20:23], v15 offset:160
    ds_read_b128 v[24:27], v15 offset:17056
    s_waitcnt lgkmcnt(0)
    v_mfma_f32_32x32x16_bf16 v[32:47], v[20:23], a[20:23], v[32:47]
    v_mfma_f32_32x32x16_bf16 v[48:63], v[24:27], a[20:23], v[48:63]
    ds_read_b128 v[20:23], v15 offset:192
    ds_read_b128 v[24:27], v15 offset:17088
    s_waitcnt lgkmcnt(0)
    v_mfma_f32_32x32x16_bf16 v[32:47], v[20:23], a[24:27], v[32:47]
    v_mfma_f32_32x32x16_bf16 v[48:63], v[24:27], a[24:27], v[48:63]
    ds_read_b128 v[20:23], v15 offset:224
    ds_read_b128 v[24:27], v15 offset:17120
    s_waitcnt lgkmcnt(0)
    v_mfma_f32_32x32x16_bf16 v[32:47], v[20:23], a[28:31], v[32:47]
    v_mfma_f32_32x32x16_bf16 v[48:63], v[24:27], a[28:31], v[48:63]
    ds_read_b128 v[20:23], v15 offset:256
    ds_read_b128 v[24:27], v15 offset:17152
    s_waitcnt lgkmcnt(0)
    v_mfma_f32_32x32x16_bf16 v[32:47], v[20:23], a[32:35], v[32:47]
    v_mfma_f32_32x32x16_bf16 v[48:63], v[24:27], a[32:35], v[48:63]
    ds_read_b128 v[20:23], v15 offset:288
    ds_read_b128 v[24:27], v15 offset:17184
    s_waitcnt lgkmcnt(0)
    v_mfma_f32_32x32x16_bf16 v[32:47], v[20:23], a[36:39], v[32:47]
    v_mfma_f32_32x32x16_bf16 v[48:63], v[24:27], a[36:39], v[48:63]
    ds_read_b128 v[20:23], v15 offset:320
    ds_read_b128 v[24:27], v15 offset:17216
    s_waitcnt lgkmcnt(0)
    v_mfma_f32_32x32x16_bf16 v[32:47], v[20:23], a[40:43], v[32:47]
    v_mfma_f32_32x32x16_bf16 v[48:63], v[24:27], a[40:43], v[48:63]
    ds_read_b128 v[20:23], v15 offset:352
    ds_read_b128 v[24:27], v15 offset:17248
    s_waitcnt lgkmcnt(0)
    v_mfma_f32_32x32x16_bf16 v[32:47], v[20:23], a[44:47], v[32:47]
    v_mfma_f32_32x32x16_bf16 v[48:63], v[24:27], a[44:47], v[48:63]
    ds_read_b128 v[20:23], v15 offset:384
    ds_read_b128 v[24:27], v15 offset:17280
    s_waitcnt lgkmcnt(0)
    v_mfma_f32_32x32x16_bf16 v[32:47], v[20:23], a[48:51], v[32:47]
    v_mfma_f32_32x32x16_bf16 v[48:63], v[24:27], a[48:51], v[48:63]
    ds_read_b128 v[20:23], v15 offset:416
    ds_read_b128 v[24:27], v15 offset:17312
    s_waitcnt lgkmcnt(0)
    v_mfma_f32_32x32x16_bf16 v[32:47], v[20:23], a[52:55], v[32:47]
    v_mfma_f32_32x32x16_bf16 v[48:63], v[24:27], a[52:55], v[48:63]
    ds_read_b128 v[20:23], v15 offset:448
    ds_read_b128 v[24:27], v15 offset:17344
    s_waitcnt lgkmcnt(0)
    v_mfma_f32_32x32x16_bf16 v[32:47], v[20:23], a[56:59], v[32:47]
    v_mfma_f32_32x32x16_bf16 v[48:63], v[24:27], a[56:59], v[48:63]
    ds_read_b128 v[20:23], v15 offset:480
    ds_read_b128 v[24:27], v15 offset:17376
    s_waitcnt lgkmcnt(0)
    v_mfma_f32_32x32x16_bf16 v[32:47], v[20:23], a[60:63], v[32:47]
    v_mfma_f32_32x32x16_bf16 v[48:63], v[24:27], a[60:63], v[48:63]
    s_nop 15
    v_lshlrev_b32 v18, 2, v4
    v_sub_u32 v18, v3, v18
    v_add_u32 v18, 8, v18
    v_mov_b32 v28, 0xf149f2ca
    v_mov_b32 v19, 0x3db8aa3b
    v_cmp_le_i32 vcc, 0, v18
    v_cndmask_b32 v32, v28, v32, vcc
    v_cmp_le_i32 vcc, 1, v18
    v_cndmask_b32 v33, v28, v33, vcc
    v_cmp_le_i32 vcc, 2, v18
    v_cndmask_b32 v34, v28, v34, vcc
    v_cmp_le_i32 vcc, 3, v18
    v_cndmask_b32 v35, v28, v35, vcc
    v_cmp_le_i32 vcc, 8, v18
    v_cndmask_b32 v36, v28, v36, vcc
    v_cmp_le_i32 vcc, 9, v18
    v_cndmask_b32 v37, v28, v37, vcc
    v_cmp_le_i32 vcc, 10, v18
    v_cndmask_b32 v38, v28, v38, vcc
    v_cmp_le_i32 vcc, 11, v18
    v_cndmask_b32 v39, v28, v39, vcc
    v_cmp_le_i32 vcc, 16, v18
    v_cndmask_b32 v40, v28, v40, vcc
    v_cmp_le_i32 vcc, 17, v18
    v_cndmask_b32 v41, v28, v41, vcc
    v_cmp_le_i32 vcc, 18, v18
    v_cndmask_b32 v42, v28, v42, vcc
    v_cmp_le_i32 vcc, 19, v18
    v_cndmask_b32 v43, v28, v43, vcc
    v_cmp_le_i32 vcc, 24, v18
    v_cndmask_b32 v44, v28, v44, vcc
    v_cmp_le_i32 vcc, 25, v18
    v_cndmask_b32 v45, v28, v45, vcc
    v_cmp_le_i32 vcc, 26, v18
    v_cndmask_b32 v46, v28, v46, vcc
    v_cmp_le_i32 vcc, 27, v18
    v_cndmask_b32 v47, v28, v47, vcc
    v_cmp_le_i32 vcc, 32, v18
    v_cndmask_b32 v48, v28, v48, vcc
    v_cmp_le_i32 vcc, 33, v18
    v_cndmask_b32 v49, v28, v49, vcc
    v_cmp_le_i32 vcc, 34, v18
    v_cndmask_b32 v50, v28, v50, vcc
    v_cmp_le_i32 vcc, 35, v18
    v_cndmask_b32 v51, v28, v51, vcc
    v_cmp_le_i32 vcc, 40, v18
    v_cndmask_b32 v52, v28, v52, vcc
    v_cmp_le_i32 vcc, 41, v18
    v_cndmask_b32 v53, v28, v53, vcc
    v_cmp_le_i32 vcc, 42, v18
    v_cndmask_b32 v54, v28, v54, vcc
    v_cmp_le_i32 vcc, 43, v18
    v_cndmask_b32 v55, v28, v55, vcc
    v_cmp_le_i32 vcc, 48, v18
    v_cndmask_b32 v56, v28, v56, vcc
    v_cmp_le_i32 vcc, 49, v18
    v_cndmask_b32 v57, v28, v57, vcc
    v_cmp_le_i32 vcc, 50, v18
    v_cndmask_b32 v58, v28, v58, vcc
    v_cmp_le_i32 vcc, 51, v18
    v_cndmask_b32 v59, v28, v59, vcc
    v_cmp_le_i32 vcc, 56, v18
    v_cndmask_b32 v60, v28, v60, vcc
    v_cmp_le_i32 vcc, 57, v18
    v_cndmask_b32 v61, v28, v61, vcc
    v_cmp_le_i32 vcc, 58, v18
    v_cndmask_b32 v62, v28, v62, vcc
    v_cmp_le_i32 vcc, 59, v18
    v_cndmask_b32 v63, v28, v63, vcc
    v_mov_b32 v20, v32
    v_max_f32 v20, v20, v33
    v_max_f32 v20, v20, v34
    v_max_f32 v20, v20, v35
    v_max_f32 v20, v20, v36
    v_max_f32 v20, v20, v37
    v_max_f32 v20, v20, v38
    v_max_f32 v20, v20, v39
    v_max_f32 v20, v20, v40
    v_max_f32 v20, v20, v41
    v_max_f32 v20, v20, v42
    v_max_f32 v20, v20, v43
    v_max_f32 v20, v20, v44
    v_max_f32 v20, v20, v45
    v_max_f32 v20, v20, v46
    v_max_f32 v20, v20, v47
    v_max_f32 v20, v20, v48
    v_max_f32 v20, v20, v49
    v_max_f32 v20, v20, v50
    v_max_f32 v20, v20, v51
    v_max_f32 v20, v20, v52
    v_max_f32 v20, v20, v53
    v_max_f32 v20, v20, v54
    v_max_f32 v20, v20, v55
    v_max_f32 v20, v20, v56
    v_max_f32 v20, v20, v57
    v_max_f32 v20, v20, v58
    v_max_f32 v20, v20, v59
    v_max_f32 v20, v20, v60
    v_max_f32 v20, v20, v61
    v_max_f32 v20, v20, v62
    v_max_f32 v20, v20, v63
    v_mov_b32 v21, v20
    s_nop 1
    v_permlane32_swap_b32 v21, v20
    v_max_f32 v20, v20, v21
    v_mov_b32 v9, 0
    v_sub_f32 v32, v32, v20
    v_mul_f32 v32, v19, v32
    v_exp_f32 v32, v32
    v_sub_f32 v33, v33, v20
    v_mul_f32 v33, v19, v33
    v_exp_f32 v33, v33
    v_sub_f32 v34, v34, v20
    v_mul_f32 v34, v19, v34
    v_exp_f32 v34, v34
    v_sub_f32 v35, v35, v20
    v_mul_f32 v35, v19, v35
    v_exp_f32 v35, v35
    v_sub_f32 v36, v36, v20
    v_mul_f32 v36, v19, v36
    v_exp_f32 v36, v36
    v_sub_f32 v37, v37, v20
    v_mul_f32 v37, v19, v37
    v_exp_f32 v37, v37
    v_sub_f32 v38, v38, v20
    v_mul_f32 v38, v19, v38
    v_exp_f32 v38, v38
    v_sub_f32 v39, v39, v20
    v_mul_f32 v39, v19, v39
    v_exp_f32 v39, v39
    v_sub_f32 v40, v40, v20
    v_mul_f32 v40, v19, v40
    v_exp_f32 v40, v40
    v_sub_f32 v41, v41, v20
    v_mul_f32 v41, v19, v41
    v_exp_f32 v41, v41
    v_sub_f32 v42, v42, v20
    v_mul_f32 v42, v19, v42
    v_exp_f32 v42, v42
    v_sub_f32 v43, v43, v20
    v_mul_f32 v43, v19, v43
    v_exp_f32 v43, v43
    v_sub_f32 v44, v44, v20
    v_mul_f32 v44, v19, v44
    v_exp_f32 v44, v44
    v_sub_f32 v45, v45, v20
    v_mul_f32 v45, v19, v45
    v_exp_f32 v45, v45
    v_sub_f32 v46, v46, v20
    v_mul_f32 v46, v19, v46
    v_exp_f32 v46, v46
    v_sub_f32 v47, v47, v20
    v_mul_f32 v47, v19, v47
    v_exp_f32 v47, v47
    v_sub_f32 v48, v48, v20
    v_mul_f32 v48, v19, v48
    v_exp_f32 v48, v48
    v_sub_f32 v49, v49, v20
    v_mul_f32 v49, v19, v49
    v_exp_f32 v49, v49
    v_sub_f32 v50, v50, v20
    v_mul_f32 v50, v19, v50
    v_exp_f32 v50, v50
    v_sub_f32 v51, v51, v20
    v_mul_f32 v51, v19, v51
    v_exp_f32 v51, v51
    v_sub_f32 v52, v52, v20
    v_mul_f32 v52, v19, v52
    v_exp_f32 v52, v52
    v_sub_f32 v53, v53, v20
    v_mul_f32 v53, v19, v53
    v_exp_f32 v53, v53
    v_sub_f32 v54, v54, v20
    v_mul_f32 v54, v19, v54
    v_exp_f32 v54, v54
    v_sub_f32 v55, v55, v20
    v_mul_f32 v55, v19, v55
    v_exp_f32 v55, v55
    v_sub_f32 v56, v56, v20
    v_mul_f32 v56, v19, v56
    v_exp_f32 v56, v56
    v_sub_f32 v57, v57, v20
    v_mul_f32 v57, v19, v57
    v_exp_f32 v57, v57
    v_sub_f32 v58, v58, v20
    v_mul_f32 v58, v19, v58
    v_exp_f32 v58, v58
    v_sub_f32 v59, v59, v20
    v_mul_f32 v59, v19, v59
    v_exp_f32 v59, v59
    v_sub_f32 v60, v60, v20
    v_mul_f32 v60, v19, v60
    v_exp_f32 v60, v60
    v_sub_f32 v61, v61, v20
    v_mul_f32 v61, v19, v61
    v_exp_f32 v61, v61
    v_sub_f32 v62, v62, v20
    v_mul_f32 v62, v19, v62
    v_exp_f32 v62, v62
    v_sub_f32 v63, v63, v20
    v_mul_f32 v63, v19, v63
    v_exp_f32 v63, v63
    s_nop 0
    v_add_f32 v9, v9, v32
    v_add_f32 v9, v9, v33
    v_add_f32 v9, v9, v34
    v_add_f32 v9, v9, v35
    v_add_f32 v9, v9, v36
    v_add_f32 v9, v9, v37
    v_add_f32 v9, v9, v38
    v_add_f32 v9, v9, v39
    v_add_f32 v9, v9, v40
    v_add_f32 v9, v9, v41
    v_add_f32 v9, v9, v42
    v_add_f32 v9, v9, v43
    v_add_f32 v9, v9, v44
    v_add_f32 v9, v9, v45
    v_add_f32 v9, v9, v46
    v_add_f32 v9, v9, v47
    v_add_f32 v9, v9, v48
    v_add_f32 v9, v9, v49
    v_add_f32 v9, v9, v50
    v_add_f32 v9, v9, v51
    v_add_f32 v9, v9, v52
    v_add_f32 v9, v9, v53
    v_add_f32 v9, v9, v54
    v_add_f32 v9, v9, v55
    v_add_f32 v9, v9, v56
    v_add_f32 v9, v9, v57
    v_add_f32 v9, v9, v58
    v_add_f32 v9, v9, v59
    v_add_f32 v9, v9, v60
    v_add_f32 v9, v9, v61
    v_add_f32 v9, v9, v62
    v_add_f32 v9, v9, v63
    v_mov_b32 v21, v9
    s_nop 1
    v_permlane32_swap_b32 v21, v9
    v_add_f32 v9, v9, v21
    v_rcp_f32 v9, v9
    s_nop 0
    v_mul_f32 v32, v9, v32
    v_mul_f32 v33, v9, v33
    v_mul_f32 v34, v9, v34
    v_mul_f32 v35, v9, v35
    v_mul_f32 v36, v9, v36
    v_mul_f32 v37, v9, v37
    v_mul_f32 v38, v9, v38
    v_mul_f32 v39, v9, v39
    v_mul_f32 v40, v9, v40
    v_mul_f32 v41, v9, v41
    v_mul_f32 v42, v9, v42
    v_mul_f32 v43, v9, v43
    v_mul_f32 v44, v9, v44
    v_mul_f32 v45, v9, v45
    v_mul_f32 v46, v9, v46
    v_mul_f32 v47, v9, v47
    v_mul_f32 v48, v9, v48
    v_mul_f32 v49, v9, v49
    v_mul_f32 v50, v9, v50
    v_mul_f32 v51, v9, v51
    v_mul_f32 v52, v9, v52
    v_mul_f32 v53, v9, v53
    v_mul_f32 v54, v9, v54
    v_mul_f32 v55, v9, v55
    v_mul_f32 v56, v9, v56
    v_mul_f32 v57, v9, v57
    v_mul_f32 v58, v9, v58
    v_mul_f32 v59, v9, v59
    v_mul_f32 v60, v9, v60
    v_mul_f32 v61, v9, v61
    v_mul_f32 v62, v9, v62
    v_mul_f32 v63, v9, v63
    v_cvt_pk_bf16_f32 v32, v32, v33
    v_cvt_pk_bf16_f32 v33, v34, v35
    v_cvt_pk_bf16_f32 v34, v36, v37
    v_cvt_pk_bf16_f32 v35, v38, v39
    v_cvt_pk_bf16_f32 v36, v40, v41
    v_cvt_pk_bf16_f32 v37, v42, v43
    v_cvt_pk_bf16_f32 v38, v44, v45
    v_cvt_pk_bf16_f32 v39, v46, v47
    v_cvt_pk_bf16_f32 v40, v48, v49
    v_cvt_pk_bf16_f32 v41, v50, v51
    v_cvt_pk_bf16_f32 v42, v52, v53
    v_cvt_pk_bf16_f32 v43, v54, v55
    v_cvt_pk_bf16_f32 v44, v56, v57
    v_cvt_pk_bf16_f32 v45, v58, v59
    v_cvt_pk_bf16_f32 v46, v60, v61
    v_cvt_pk_bf16_f32 v47, v62, v63
    s_nop 1
    ds_read_b64_tr_b16 v[24:25], v17 offset:0
    ds_read_b64_tr_b16 v[26:27], v17 offset:4608
    s_waitcnt lgkmcnt(0)
    v_mfma_f32_32x32x16_bf16 v[128:143], v[24:27], v[32:35], v[128:143]
    ds_read_b64_tr_b16 v[24:25], v17 offset:64
    ds_read_b64_tr_b16 v[26:27], v17 offset:4672
    s_waitcnt lgkmcnt(0)
    v_mfma_f32_32x32x16_bf16 v[144:159], v[24:27], v[32:35], v[144:159]
    ds_read_b64_tr_b16 v[24:25], v17 offset:128
    ds_read_b64_tr_b16 v[26:27], v17 offset:4736
    s_waitcnt lgkmcnt(0)
    v_mfma_f32_32x32x16_bf16 v[160:175], v[24:27], v[32:35], v[160:175]
    ds_read_b64_tr_b16 v[24:25], v17 offset:192
    ds_read_b64_tr_b16 v[26:27], v17 offset:4800
    s_waitcnt lgkmcnt(0)
    v_mfma_f32_32x32x16_bf16 v[176:191], v[24:27], v[32:35], v[176:191]
    ds_read_b64_tr_b16 v[24:25], v17 offset:256
    ds_read_b64_tr_b16 v[26:27], v17 offset:4864
    s_waitcnt lgkmcnt(0)
    v_mfma_f32_32x32x16_bf16 v[192:207], v[24:27], v[32:35], v[192:207]
    ds_read_b64_tr_b16 v[24:25], v17 offset:320
    ds_read_b64_tr_b16 v[26:27], v17 offset:4928
    s_waitcnt lgkmcnt(0)
    v_mfma_f32_32x32x16_bf16 v[208:223], v[24:27], v[32:35], v[208:223]
    ds_read_b64_tr_b16 v[24:25], v17 offset:384
    ds_read_b64_tr_b16 v[26:27], v17 offset:4992
    s_waitcnt lgkmcnt(0)
    v_mfma_f32_32x32x16_bf16 v[224:239], v[24:27], v[32:35], v[224:239]
    ds_read_b64_tr_b16 v[24:25], v17 offset:448
    ds_read_b64_tr_b16 v[26:27], v17 offset:5056
    s_waitcnt lgkmcnt(0)
    v_mfma_f32_32x32x16_bf16 v[240:255], v[24:27], v[32:35], v[240:255]
    ds_read_b64_tr_b16 v[24:25], v17 offset:9216
    ds_read_b64_tr_b16 v[26:27], v17 offset:13824
    s_waitcnt lgkmcnt(0)
    v_mfma_f32_32x32x16_bf16 v[128:143], v[24:27], v[36:39], v[128:143]
    ds_read_b64_tr_b16 v[24:25], v17 offset:9280
    ds_read_b64_tr_b16 v[26:27], v17 offset:13888
    s_waitcnt lgkmcnt(0)
    v_mfma_f32_32x32x16_bf16 v[144:159], v[24:27], v[36:39], v[144:159]
    ds_read_b64_tr_b16 v[24:25], v17 offset:9344
    ds_read_b64_tr_b16 v[26:27], v17 offset:13952
    s_waitcnt lgkmcnt(0)
    v_mfma_f32_32x32x16_bf16 v[160:175], v[24:27], v[36:39], v[160:175]
    ds_read_b64_tr_b16 v[24:25], v17 offset:9408
    ds_read_b64_tr_b16 v[26:27], v17 offset:14016
    s_waitcnt lgkmcnt(0)
    v_mfma_f32_32x32x16_bf16 v[176:191], v[24:27], v[36:39], v[176:191]
    ds_read_b64_tr_b16 v[24:25], v17 offset:9472
    ds_read_b64_tr_b16 v[26:27], v17 offset:14080
    s_waitcnt lgkmcnt(0)
    v_mfma_f32_32x32x16_bf16 v[192:207], v[24:27], v[36:39], v[192:207]
    ds_read_b64_tr_b16 v[24:25], v17 offset:9536
    ds_read_b64_tr_b16 v[26:27], v17 offset:14144
    s_waitcnt lgkmcnt(0)
    v_mfma_f32_32x32x16_bf16 v[208:223], v[24:27], v[36:39], v[208:223]
    ds_read_b64_tr_b16 v[24:25], v17 offset:9600
    ds_read_b64_tr_b16 v[26:27], v17 offset:14208
    s_waitcnt lgkmcnt(0)
    v_mfma_f32_32x32x16_bf16 v[224:239], v[24:27], v[36:39], v[224:239]
    ds_read_b64_tr_b16 v[24:25], v17 offset:9664
    ds_read_b64_tr_b16 v[26:27], v17 offset:14272
    s_waitcnt lgkmcnt(0)
    v_mfma_f32_32x32x16_bf16 v[240:255], v[24:27], v[36:39], v[240:255]
    ds_read_b64_tr_b16 v[24:25], v17 offset:18432
    ds_read_b64_tr_b16 v[26:27], v17 offset:23040
    s_waitcnt lgkmcnt(0)
    v_mfma_f32_32x32x16_bf16 v[128:143], v[24:27], v[40:43], v[128:143]
    ds_read_b64_tr_b16 v[24:25], v17 offset:18496
    ds_read_b64_tr_b16 v[26:27], v17 offset:23104
    s_waitcnt lgkmcnt(0)
    v_mfma_f32_32x32x16_bf16 v[144:159], v[24:27], v[40:43], v[144:159]
    ds_read_b64_tr_b16 v[24:25], v17 offset:18560
    ds_read_b64_tr_b16 v[26:27], v17 offset:23168
    s_waitcnt lgkmcnt(0)
    v_mfma_f32_32x32x16_bf16 v[160:175], v[24:27], v[40:43], v[160:175]
    ds_read_b64_tr_b16 v[24:25], v17 offset:18624
    ds_read_b64_tr_b16 v[26:27], v17 offset:23232
    s_waitcnt lgkmcnt(0)
    v_mfma_f32_32x32x16_bf16 v[176:191], v[24:27], v[40:43], v[176:191]
    ds_read_b64_tr_b16 v[24:25], v17 offset:18688
    ds_read_b64_tr_b16 v[26:27], v17 offset:23296
    s_waitcnt lgkmcnt(0)
    v_mfma_f32_32x32x16_bf16 v[192:207], v[24:27], v[40:43], v[192:207]
    ds_read_b64_tr_b16 v[24:25], v17 offset:18752
    ds_read_b64_tr_b16 v[26:27], v17 offset:23360
    s_waitcnt lgkmcnt(0)
    v_mfma_f32_32x32x16_bf16 v[208:223], v[24:27], v[40:43], v[208:223]
    ds_read_b64_tr_b16 v[24:25], v17 offset:18816
    ds_read_b64_tr_b16 v[26:27], v17 offset:23424
    s_waitcnt lgkmcnt(0)
    v_mfma_f32_32x32x16_bf16 v[224:239], v[24:27], v[40:43], v[224:239]
    ds_read_b64_tr_b16 v[24:25], v17 offset:18880
    ds_read_b64_tr_b16 v[26:27], v17 offset:23488
    s_waitcnt lgkmcnt(0)
    v_mfma_f32_32x32x16_bf16 v[240:255], v[24:27], v[40:43], v[240:255]
    ds_read_b64_tr_b16 v[24:25], v17 offset:27648
    ds_read_b64_tr_b16 v[26:27], v17 offset:32256
    s_waitcnt lgkmcnt(0)
    v_mfma_f32_32x32x16_bf16 v[128:143], v[24:27], v[44:47], v[128:143]
    ds_read_b64_tr_b16 v[24:25], v17 offset:27712
    ds_read_b64_tr_b16 v[26:27], v17 offset:32320
    s_waitcnt lgkmcnt(0)
    v_mfma_f32_32x32x16_bf16 v[144:159], v[24:27], v[44:47], v[144:159]
    ds_read_b64_tr_b16 v[24:25], v17 offset:27776
    ds_read_b64_tr_b16 v[26:27], v17 offset:32384
    s_waitcnt lgkmcnt(0)
    v_mfma_f32_32x32x16_bf16 v[160:175], v[24:27], v[44:47], v[160:175]
    ds_read_b64_tr_b16 v[24:25], v17 offset:27840
    ds_read_b64_tr_b16 v[26:27], v17 offset:32448
    s_waitcnt lgkmcnt(0)
    v_mfma_f32_32x32x16_bf16 v[176:191], v[24:27], v[44:47], v[176:191]
    ds_read_b64_tr_b16 v[24:25], v17 offset:27904
    ds_read_b64_tr_b16 v[26:27], v17 offset:32512
    s_waitcnt lgkmcnt(0)
    v_mfma_f32_32x32x16_bf16 v[192:207], v[24:27], v[44:47], v[192:207]
    ds_read_b64_tr_b16 v[24:25], v17 offset:27968
    ds_read_b64_tr_b16 v[26:27], v17 offset:32576
    s_waitcnt lgkmcnt(0)
    v_mfma_f32_32x32x16_bf16 v[208:223], v[24:27], v[44:47], v[208:223]
    ds_read_b64_tr_b16 v[24:25], v17 offset:28032
    ds_read_b64_tr_b16 v[26:27], v17 offset:32640
    s_waitcnt lgkmcnt(0)
    v_mfma_f32_32x32x16_bf16 v[224:239], v[24:27], v[44:47], v[224:239]
    ds_read_b64_tr_b16 v[24:25], v17 offset:28096
    ds_read_b64_tr_b16 v[26:27], v17 offset:32704
    s_waitcnt lgkmcnt(0)
    v_mfma_f32_32x32x16_bf16 v[240:255], v[24:27], v[44:47], v[240:255]
    s_nop 15
    v_lshlrev_b32 v6, 13, v5
    v_lshl_add_u32 v6, v4, 3, v6
    v_lshl_add_u32 v6, v7, 9, v6
    v_add_u32 v6, 117440512, v6
    v_cvt_pk_bf16_f32 v128, v128, v129
    v_cvt_pk_bf16_f32 v129, v130, v131
    global_store_dwordx2 v6, v[128:129], s[46:47] offset:0
    v_cvt_pk_bf16_f32 v132, v132, v133
    v_cvt_pk_bf16_f32 v133, v134, v135
    global_store_dwordx2 v6, v[132:133], s[46:47] offset:16
    v_cvt_pk_bf16_f32 v136, v136, v137
    v_cvt_pk_bf16_f32 v137, v138, v139
    global_store_dwordx2 v6, v[136:137], s[46:47] offset:32
    v_cvt_pk_bf16_f32 v140, v140, v141
    v_cvt_pk_bf16_f32 v141, v142, v143
    global_store_dwordx2 v6, v[140:141], s[46:47] offset:48
    v_cvt_pk_bf16_f32 v144, v144, v145
    v_cvt_pk_bf16_f32 v145, v146, v147
    global_store_dwordx2 v6, v[144:145], s[46:47] offset:64
    v_cvt_pk_bf16_f32 v148, v148, v149
    v_cvt_pk_bf16_f32 v149, v150, v151
    global_store_dwordx2 v6, v[148:149], s[46:47] offset:80
    v_cvt_pk_bf16_f32 v152, v152, v153
    v_cvt_pk_bf16_f32 v153, v154, v155
    global_store_dwordx2 v6, v[152:153], s[46:47] offset:96
    v_cvt_pk_bf16_f32 v156, v156, v157
    v_cvt_pk_bf16_f32 v157, v158, v159
    global_store_dwordx2 v6, v[156:157], s[46:47] offset:112
    v_cvt_pk_bf16_f32 v160, v160, v161
    v_cvt_pk_bf16_f32 v161, v162, v163
    global_store_dwordx2 v6, v[160:161], s[46:47] offset:128
    v_cvt_pk_bf16_f32 v164, v164, v165
    v_cvt_pk_bf16_f32 v165, v166, v167
    global_store_dwordx2 v6, v[164:165], s[46:47] offset:144
    v_cvt_pk_bf16_f32 v168, v168, v169
    v_cvt_pk_bf16_f32 v169, v170, v171
    global_store_dwordx2 v6, v[168:169], s[46:47] offset:160
    v_cvt_pk_bf16_f32 v172, v172, v173
    v_cvt_pk_bf16_f32 v173, v174, v175
    global_store_dwordx2 v6, v[172:173], s[46:47] offset:176
    v_cvt_pk_bf16_f32 v176, v176, v177
    v_cvt_pk_bf16_f32 v177, v178, v179
    global_store_dwordx2 v6, v[176:177], s[46:47] offset:192
    v_cvt_pk_bf16_f32 v180, v180, v181
    v_cvt_pk_bf16_f32 v181, v182, v183
    global_store_dwordx2 v6, v[180:181], s[46:47] offset:208
    v_cvt_pk_bf16_f32 v184, v184, v185
    v_cvt_pk_bf16_f32 v185, v186, v187
    global_store_dwordx2 v6, v[184:185], s[46:47] offset:224
    v_cvt_pk_bf16_f32 v188, v188, v189
    v_cvt_pk_bf16_f32 v189, v190, v191
    global_store_dwordx2 v6, v[188:189], s[46:47] offset:240
    v_cvt_pk_bf16_f32 v192, v192, v193
    v_cvt_pk_bf16_f32 v193, v194, v195
    global_store_dwordx2 v6, v[192:193], s[46:47] offset:256
    v_cvt_pk_bf16_f32 v196, v196, v197
    v_cvt_pk_bf16_f32 v197, v198, v199
    global_store_dwordx2 v6, v[196:197], s[46:47] offset:272
    v_cvt_pk_bf16_f32 v200, v200, v201
    v_cvt_pk_bf16_f32 v201, v202, v203
    global_store_dwordx2 v6, v[200:201], s[46:47] offset:288
    v_cvt_pk_bf16_f32 v204, v204, v205
    v_cvt_pk_bf16_f32 v205, v206, v207
    global_store_dwordx2 v6, v[204:205], s[46:47] offset:304
    v_cvt_pk_bf16_f32 v208, v208, v209
    v_cvt_pk_bf16_f32 v209, v210, v211
    global_store_dwordx2 v6, v[208:209], s[46:47] offset:320
    v_cvt_pk_bf16_f32 v212, v212, v213
    v_cvt_pk_bf16_f32 v213, v214, v215
    global_store_dwordx2 v6, v[212:213], s[46:47] offset:336
    v_cvt_pk_bf16_f32 v216, v216, v217
    v_cvt_pk_bf16_f32 v217, v218, v219
    global_store_dwordx2 v6, v[216:217], s[46:47] offset:352
    v_cvt_pk_bf16_f32 v220, v220, v221
    v_cvt_pk_bf16_f32 v221, v222, v223
    global_store_dwordx2 v6, v[220:221], s[46:47] offset:368
    v_cvt_pk_bf16_f32 v224, v224, v225
    v_cvt_pk_bf16_f32 v225, v226, v227
    global_store_dwordx2 v6, v[224:225], s[46:47] offset:384
    v_cvt_pk_bf16_f32 v228, v228, v229
    v_cvt_pk_bf16_f32 v229, v230, v231
    global_store_dwordx2 v6, v[228:229], s[46:47] offset:400
    v_cvt_pk_bf16_f32 v232, v232, v233
    v_cvt_pk_bf16_f32 v233, v234, v235
    global_store_dwordx2 v6, v[232:233], s[46:47] offset:416
    v_cvt_pk_bf16_f32 v236, v236, v237
    v_cvt_pk_bf16_f32 v237, v238, v239
    global_store_dwordx2 v6, v[236:237], s[46:47] offset:432
    v_cvt_pk_bf16_f32 v240, v240, v241
    v_cvt_pk_bf16_f32 v241, v242, v243
    global_store_dwordx2 v6, v[240:241], s[46:47] offset:448
    v_cvt_pk_bf16_f32 v244, v244, v245
    v_cvt_pk_bf16_f32 v245, v246, v247
    global_store_dwordx2 v6, v[244:245], s[46:47] offset:464
    v_cvt_pk_bf16_f32 v248, v248, v249
    v_cvt_pk_bf16_f32 v249, v250, v251
    global_store_dwordx2 v6, v[248:249], s[46:47] offset:480
    v_cvt_pk_bf16_f32 v252, v252, v253
    v_cvt_pk_bf16_f32 v253, v254, v255
    global_store_dwordx2 v6, v[252:253], s[46:47] offset:496
aadone_29:
    s_endpgm
.globl oproj_kernel
.p2align 8
.type oproj_kernel,@function
oproj_kernel:
    s_cmp_ge_u32 s2, 128
    s_cbranch_scc1 opdone_30
    s_load_dwordx16 s[16:31], s[0:1], 0
    s_load_dwordx16 s[32:47], s[0:1], 64
    s_lshr_b32 s54, s2, 6
    s_and_b32 s55, s2, 63
    s_and_b32 s56, s55, 3
    s_lshr_b32 s57, s55, 2
    s_waitcnt lgkmcnt(0)
    s_cmp_eq_u32 s54, 0
    s_cbranch_scc0 opnx_32
    s_add_u32 s4, s46, 117440512
    s_addc_u32 s5, s47, 0
    s_mov_b32 s6, 16777216
    s_add_u32 s8, s26, 0
    s_addc_u32 s9, s27, 0
    s_mov_b32 s10, 3670016
    s_add_u32 s12, s42, 0
    s_addc_u32 s13, s43, 0
    s_mov_b32 s14, 3670016
    s_mov_b32 s48, 8192
    s_mov_b32 s49, 896
    s_mov_b32 s50, 1792
    s_mov_b32 s51, 64
    s_branch opgo_31
opnx_32:
    s_cmp_eq_u32 s54, 1
    s_cbranch_scc0 opnx_33
    s_add_u32 s4, s46, 100663296
    s_addc_u32 s5, s47, 0
    s_mov_b32 s6, 16777216
    s_add_u32 s8, s40, 0
    s_addc_u32 s9, s41, 0
    s_mov_b32 s10, 3670016
    s_add_u32 s12, s42, 896
    s_addc_u32 s13, s43, 0
    s_mov_b32 s14, 3669120
    s_mov_b32 s48, 8192
    s_mov_b32 s49, 896
    s_mov_b32 s50, 1792
    s_mov_b32 s51, 64
    s_branch opgo_31
opnx_33:
    s_branch opdone_30
opgo_31:
    s_mov_b32 s7, 0x00020000
    s_mov_b32 s11, 0x00020000
    s_mov_b32 s15, 0x00020000
    v_lshrrev_b32 v1, 3, v0
    v_and_b32 v2, 7, v0
    s_lshl_b32 s58, s57, 7
    v_add_u32 v1, s58, v1
    v_mul_lo_u32 v1, v1, s48
    v_lshl_add_u32 v4, v2, 4, v1
    s_lshl_b32 s59, s48, 5
    v_add_u32 v5, s59, v4
    v_add_u32 v6, s59, v5
    v_add_u32 v7, s59, v6
    v_lshrrev_b32 v1, 3, v0
    v_mul_u32_u24 v1, 144, v1
    v_lshl_add_u32 v12, v2, 4, v1
    v_lshrrev_b32 v1, 4, v0
    v_and_b32 v2, 15, v0
    v_mul_lo_u32 v3, v1, s49
    v_lshl_add_u32 v3, v2, 4, v3
    s_lshl_b32 s59, s56, 8
    v_add_u32 v8, s59, v3
    s_lshl_b32 s59, s49, 4
    v_add_u32 v9, s59, v8
    v_add_u32 v10, s59, v9
    v_add_u32 v11, s59, v10
    v_mul_u32_u24 v1, 320, v1
    v_lshl_add_u32 v13, v2, 4, v1
    v_add_u32 v13, 18432, v13
    v_lshrrev_b32 v1, 6, v0
    v_and_b32 v2, 63, v0
    v_lshrrev_b32 v3, 1, v1
    v_and_b32 v1, 1, v1
    v_and_b32 v14, 31, v2
    v_lshl_add_u32 v14, v3, 6, v14
    v_mul_u32_u24 v14, 144, v14
    v_lshrrev_b32 v15, 5, v2
    v_lshl_add_u32 v14, v15, 4, v14
    v_and_b32 v16, 15, v2
    v_lshrrev_b32 v17, 2, v16
    v_lshl_add_u32 v17, v15, 3, v17
    v_mul_u32_u24 v17, 320, v17
    v_and_b32 v16, 3, v16
    v_lshlrev_b32 v16, 3, v16
    v_add_u32 v17, v17, v16
    v_bfe_u32 v16, v2, 4, 1
    v_lshl_add_u32 v17, v16, 5, v17
    v_lshl_add_u32 v17, v1, 7, v17
    v_add_u32 v17, 18432, v17
    v_and_b32 v18, 31, v2
    v_lshl_add_u32 v18, v3, 6, v18
    v_add_u32 v18, s58, v18
    v_mul_lo_u32 v18, v18, s50
    v_lshl_add_u32 v18, v15, 3, v18
    v_lshl_add_u32 v18, v1, 7, v18
    s_lshl_b32 s59, s56, 8
    v_add_u32 v18, s59, v18
    v_mov_b32 v64, 0
    v_mov_b32 v65, 0
    v_mov_b32 v66, 0
    v_mov_b32 v67, 0
    v_mov_b32 v68, 0
    v_mov_b32 v69, 0
    v_mov_b32 v70, 0
    v_mov_b32 v71, 0
    v_mov_b32 v72, 0
    v_mov_b32 v73, 0
    v_mov_b32 v74, 0
    v_mov_b32 v75, 0
    v_mov_b32 v76, 0
    v_mov_b32 v77, 0
    v_mov_b32 v78, 0
    v_mov_b32 v79, 0
    v_mov_b32 v80, 0
    v_mov_b32 v81, 0
    v_mov_b32 v82, 0
    v_mov_b32 v83, 0
    v_mov_b32 v84, 0
    v_mov_b32 v85, 0
    v_mov_b32 v86, 0
    v_mov_b32 v87, 0
    v_mov_b32 v88, 0
    v_mov_b32 v89, 0
    v_mov_b32 v90, 0
    v_mov_b32 v91, 0
    v_mov_b32 v92, 0
    v_mov_b32 v93, 0
    v_mov_b32 v94, 0
    v_mov_b32 v95, 0
    v_mov_b32 v96, 0
    v_mov_b32 v97, 0
    v_mov_b32 v98, 0
    v_mov_b32 v99, 0
    v_mov_b32 v100, 0
    v_mov_b32 v101, 0
    v_mov_b32 v102, 0
    v_mov_b32 v103, 0
    v_mov_b32 v104, 0
    v_mov_b32 v105, 0
    v_mov_b32 v106, 0
    v_mov_b32 v107, 0
    v_mov_b32 v108, 0
    v_mov_b32 v109, 0
    v_mov_b32 v110, 0
    v_mov_b32 v111, 0
    v_mov_b32 v112, 0
    v_mov_b32 v113, 0
    v_mov_b32 v114, 0
    v_mov_b32 v115, 0
    v_mov_b32 v116, 0
    v_mov_b32 v117, 0
    v_mov_b32 v118, 0
    v_mov_b32 v119, 0
    v_mov_b32 v120, 0
    v_mov_b32 v121, 0
    v_mov_b32 v122, 0
    v_mov_b32 v123, 0
    v_mov_b32 v124, 0
    v_mov_b32 v125, 0
    v_mov_b32 v126, 0
    v_mov_b32 v127, 0
    s_mov_b32 s52, 0
    s_mov_b32 s53, 0
    s_lshl_b32 s60, s49, 6
    buffer_load_dwordx4 v[32:35], v4, s[4:7], s52 offen
    buffer_load_dwordx4 v[36:39], v5, s[4:7], s52 offen
    buffer_load_dwordx4 v[40:43], v6, s[4:7], s52 offen
    buffer_load_dwordx4 v[44:47], v7, s[4:7], s52 offen
    buffer_load_dwordx4 v[48:51], v8, s[8:11], s53 offen
    buffer_load_dwordx4 v[52:55], v9, s[8:11], s53 offen
    buffer_load_dwordx4 v[56:59], v10, s[8:11], s53 offen
    buffer_load_dwordx4 v[60:63], v11, s[8:11], s53 offen
    s_add_u32 s52, s52, 128
    s_add_u32 s53, s53, s60
    s_waitcnt vmcnt(0)
    ds_write_b128 v12, v[32:35] offset:0
    ds_write_b128 v12, v[36:39] offset:4608
    ds_write_b128 v12, v[40:43] offset:9216
    ds_write_b128 v12, v[44:47] offset:13824
    ds_write_b128 v13, v[48:51] offset:0
    ds_write_b128 v13, v[52:55] offset:5120
    ds_write_b128 v13, v[56:59] offset:10240
    ds_write_b128 v13, v[60:63] offset:15360
    s_waitcnt lgkmcnt(0)
    s_barrier
oploop_34:
    s_sub_u32 s51, s51, 1
    s_cmp_eq_u32 s51, 0
    s_cbranch_scc1 opnol_35
    buffer_load_dwordx4 v[32:35], v4, s[4:7], s52 offen
    buffer_load_dwordx4 v[36:39], v5, s[4:7], s52 offen
    buffer_load_dwordx4 v[40:43], v6, s[4:7], s52 offen
    buffer_load_dwordx4 v[44:47], v7, s[4:7], s52 offen
    buffer_load_dwordx4 v[48:51], v8, s[8:11], s53 offen
    buffer_load_dwordx4 v[52:55], v9, s[8:11], s53 offen
    buffer_load_dwordx4 v[56:59], v10, s[8:11], s53 offen
    buffer_load_dwordx4 v[60:63], v11, s[8:11], s53 offen
    s_add_u32 s52, s52, 128
    s_add_u32 s53, s53, s60
opnol_35:
    ds_read_b64_tr_b16 v[128:129], v17 offset:0
    ds_read_b64_tr_b16 v[130:131], v17 offset:1280
    ds_read_b64_tr_b16 v[132:133], v17 offset:64
    ds_read_b64_tr_b16 v[134:135], v17 offset:1344
    ds_read_b128 v[136:139], v14 offset:0
    ds_read_b128 v[140:143], v14 offset:4608
    ds_read_b64_tr_b16 v[144:145], v17 offset:5120
    ds_read_b64_tr_b16 v[146:147], v17 offset:6400
    ds_read_b64_tr_b16 v[148:149], v17 offset:5184
    ds_read_b64_tr_b16 v[150:151], v17 offset:6464
    ds_read_b128 v[152:155], v14 offset:32
    ds_read_b128 v[156:159], v14 offset:4640
    s_waitcnt lgkmcnt(6)
    v_mfma_f32_32x32x16_bf16 v[64:79], v[128:131], v[136:139], v[64:79]
    v_mfma_f32_32x32x16_bf16 v[80:95], v[128:131], v[140:143], v[80:95]
    v_mfma_f32_32x32x16_bf16 v[96:111], v[132:135], v[136:139], v[96:111]
    v_mfma_f32_32x32x16_bf16 v[112:127], v[132:135], v[140:143], v[112:127]
    ds_read_b64_tr_b16 v[128:129], v17 offset:10240
    ds_read_b64_tr_b16 v[130:131], v17 offset:11520
    ds_read_b64_tr_b16 v[132:133], v17 offset:10304
    ds_read_b64_tr_b16 v[134:135], v17 offset:11584
    ds_read_b128 v[136:139], v14 offset:64
    ds_read_b128 v[140:143], v14 offset:4672
    s_waitcnt lgkmcnt(6)
    v_mfma_f32_32x32x16_bf16 v[64:79], v[144:147], v[152:155], v[64:79]
    v_mfma_f32_32x32x16_bf16 v[80:95], v[144:147], v[156:159], v[80:95]
    v_mfma_f32_32x32x16_bf16 v[96:111], v[148:151], v[152:155], v[96:111]
    v_mfma_f32_32x32x16_bf16 v[112:127], v[148:151], v[156:159], v[112:127]
    ds_read_b64_tr_b16 v[144:145], v17 offset:15360
    ds_read_b64_tr_b16 v[146:147], v17 offset:16640
    ds_read_b64_tr_b16 v[148:149], v17 offset:15424
    ds_read_b64_tr_b16 v[150:151], v17 offset:16704
    ds_read_b128 v[152:155], v14 offset:96
    ds_read_b128 v[156:159], v14 offset:4704
    s_waitcnt lgkmcnt(6)
    v_mfma_f32_32x32x16_bf16 v[64:79], v[128:131], v[136:139], v[64:79]
    v_mfma_f32_32x32x16_bf16 v[80:95], v[128:131], v[140:143], v[80:95]
    v_mfma_f32_32x32x16_bf16 v[96:111], v[132:135], v[136:139], v[96:111]
    v_mfma_f32_32x32x16_bf16 v[112:127], v[132:135], v[140:143], v[112:127]
    s_waitcnt lgkmcnt(0)
    v_mfma_f32_32x32x16_bf16 v[64:79], v[144:147], v[152:155], v[64:79]
    v_mfma_f32_32x32x16_bf16 v[80:95], v[144:147], v[156:159], v[80:95]
    v_mfma_f32_32x32x16_bf16 v[96:111], v[148:151], v[152:155], v[96:111]
    v_mfma_f32_32x32x16_bf16 v[112:127], v[148:151], v[156:159], v[112:127]
    s_cmp_eq_u32 s51, 0
    s_cbranch_scc1 op_epi
    s_waitcnt vmcnt(0)
    ds_write_b128 v12, v[32:35] offset:38912
    ds_write_b128 v12, v[36:39] offset:43520
    ds_write_b128 v12, v[40:43] offset:48128
    ds_write_b128 v12, v[44:47] offset:52736
    ds_write_b128 v13, v[48:51] offset:38912
    ds_write_b128 v13, v[52:55] offset:44032
    ds_write_b128 v13, v[56:59] offset:49152
    ds_write_b128 v13, v[60:63] offset:54272
    s_waitcnt lgkmcnt(0)
    s_barrier
    s_sub_u32 s51, s51, 1
    s_cmp_eq_u32 s51, 0
    s_cbranch_scc1 opnol_36
    buffer_load_dwordx4 v[32:35], v4, s[4:7], s52 offen
    buffer_load_dwordx4 v[36:39], v5, s[4:7], s52 offen
    buffer_load_dwordx4 v[40:43], v6, s[4:7], s52 offen
    buffer_load_dwordx4 v[44:47], v7, s[4:7], s52 offen
    buffer_load_dwordx4 v[48:51], v8, s[8:11], s53 offen
    buffer_load_dwordx4 v[52:55], v9, s[8:11], s53 offen
    buffer_load_dwordx4 v[56:59], v10, s[8:11], s53 offen
    buffer_load_dwordx4 v[60:63], v11, s[8:11], s53 offen
    s_add_u32 s52, s52, 128
    s_add_u32 s53, s53, s60
opnol_36:
    ds_read_b64_tr_b16 v[128:129], v17 offset:38912
    ds_read_b64_tr_b16 v[130:131], v17 offset:40192
    ds_read_b64_tr_b16 v[132:133], v17 offset:38976
    ds_read_b64_tr_b16 v[134:135], v17 offset:40256
    ds_read_b128 v[136:139], v14 offset:38912
    ds_read_b128 v[140:143], v14 offset:43520
    ds_read_b64_tr_b16 v[144:145], v17 offset:44032
    ds_read_b64_tr_b16 v[146:147], v17 offset:45312
    ds_read_b64_tr_b16 v[148:149], v17 offset:44096
    ds_read_b64_tr_b16 v[150:151], v17 offset:45376
    ds_read_b128 v[152:155], v14 offset:38944
    ds_read_b128 v[156:159], v14 offset:43552
    s_waitcnt lgkmcnt(6)
    v_mfma_f32_32x32x16_bf16 v[64:79], v[128:131], v[136:139], v[64:79]
    v_mfma_f32_32x32x16_bf16 v[80:95], v[128:131], v[140:143], v[80:95]
    v_mfma_f32_32x32x16_bf16 v[96:111], v[132:135], v[136:139], v[96:111]
    v_mfma_f32_32x32x16_bf16 v[112:127], v[132:135], v[140:143], v[112:127]
    ds_read_b64_tr_b16 v[128:129], v17 offset:49152
    ds_read_b64_tr_b16 v[130:131], v17 offset:50432
    ds_read_b64_tr_b16 v[132:133], v17 offset:49216
    ds_read_b64_tr_b16 v[134:135], v17 offset:50496
    ds_read_b128 v[136:139], v14 offset:38976
    ds_read_b128 v[140:143], v14 offset:43584
    s_waitcnt lgkmcnt(6)
    v_mfma_f32_32x32x16_bf16 v[64:79], v[144:147], v[152:155], v[64:79]
    v_mfma_f32_32x32x16_bf16 v[80:95], v[144:147], v[156:159], v[80:95]
    v_mfma_f32_32x32x16_bf16 v[96:111], v[148:151], v[152:155], v[96:111]
    v_mfma_f32_32x32x16_bf16 v[112:127], v[148:151], v[156:159], v[112:127]
    ds_read_b64_tr_b16 v[144:145], v17 offset:54272
    ds_read_b64_tr_b16 v[146:147], v17 offset:55552
    ds_read_b64_tr_b16 v[148:149], v17 offset:54336
    ds_read_b64_tr_b16 v[150:151], v17 offset:55616
    ds_read_b128 v[152:155], v14 offset:39008
    ds_read_b128 v[156:159], v14 offset:43616
    s_waitcnt lgkmcnt(6)
    v_mfma_f32_32x32x16_bf16 v[64:79], v[128:131], v[136:139], v[64:79]
    v_mfma_f32_32x32x16_bf16 v[80:95], v[128:131], v[140:143], v[80:95]
    v_mfma_f32_32x32x16_bf16 v[96:111], v[132:135], v[136:139], v[96:111]
    v_mfma_f32_32x32x16_bf16 v[112:127], v[132:135], v[140:143], v[112:127]
    s_waitcnt lgkmcnt(0)
    v_mfma_f32_32x32x16_bf16 v[64:79], v[144:147], v[152:155], v[64:79]
    v_mfma_f32_32x32x16_bf16 v[80:95], v[144:147], v[156:159], v[80:95]
    v_mfma_f32_32x32x16_bf16 v[96:111], v[148:151], v[152:155], v[96:111]
    v_mfma_f32_32x32x16_bf16 v[112:127], v[148:151], v[156:159], v[112:127]
    s_cmp_eq_u32 s51, 0
    s_cbranch_scc1 op_epi
    s_waitcnt vmcnt(0)
    ds_write_b128 v12, v[32:35] offset:0
    ds_write_b128 v12, v[36:39] offset:4608
    ds_write_b128 v12, v[40:43] offset:9216
    ds_write_b128 v12, v[44:47] offset:13824
    ds_write_b128 v13, v[48:51] offset:0
    ds_write_b128 v13, v[52:55] offset:5120
    ds_write_b128 v13, v[56:59] offset:10240
    ds_write_b128 v13, v[60:63] offset:15360
    s_waitcnt lgkmcnt(0)
    s_barrier
    s_branch oploop_34
op_epi:
    s_nop 15
    v_readfirstlane_b32 s59, v1
    s_nop 3
    s_lshl_b32 s58, s56, 1
    s_add_u32 s58, s58, s59
    s_cmp_ge_u32 s58, 7
    s_cbranch_scc1 opdone_30
    v_cvt_pk_bf16_f32 v20, v64, v65
    v_cvt_pk_bf16_f32 v21, v66, v67
    buffer_store_dwordx2 v[20:21], v18, s[12:15], 0 offen offset:0
    s_nop 1
    v_cvt_pk_bf16_f32 v20, v68, v69
    v_cvt_pk_bf16_f32 v21, v70, v71
    buffer_store_dwordx2 v[20:21], v18, s[12:15], 0 offen offset:16
    s_nop 1
    v_cvt_pk_bf16_f32 v20, v72, v73
    v_cvt_pk_bf16_f32 v21, v74, v75
    buffer_store_dwordx2 v[20:21], v18, s[12:15], 0 offen offset:32
    s_nop 1
    v_cvt_pk_bf16_f32 v20, v76, v77
    v_cvt_pk_bf16_f32 v21, v78, v79
    buffer_store_dwordx2 v[20:21], v18, s[12:15], 0 offen offset:48
    s_nop 1
    v_cvt_pk_bf16_f32 v20, v80, v81
    v_cvt_pk_bf16_f32 v21, v82, v83
    s_lshl_b32 s59, s50, 5
    buffer_store_dwordx2 v[20:21], v18, s[12:15], s59 offen offset:0
    s_nop 1
    v_cvt_pk_bf16_f32 v20, v84, v85
    v_cvt_pk_bf16_f32 v21, v86, v87
    s_lshl_b32 s59, s50, 5
    buffer_store_dwordx2 v[20:21], v18, s[12:15], s59 offen offset:16
    s_nop 1
    v_cvt_pk_bf16_f32 v20, v88, v89
    v_cvt_pk_bf16_f32 v21, v90, v91
    s_lshl_b32 s59, s50, 5
    buffer_store_dwordx2 v[20:21], v18, s[12:15], s59 offen offset:32
    s_nop 1
    v_cvt_pk_bf16_f32 v20, v92, v93
    v_cvt_pk_bf16_f32 v21, v94, v95
    s_lshl_b32 s59, s50, 5
    buffer_store_dwordx2 v[20:21], v18, s[12:15], s59 offen offset:48
    s_nop 1
    v_cvt_pk_bf16_f32 v20, v96, v97
    v_cvt_pk_bf16_f32 v21, v98, v99
    buffer_store_dwordx2 v[20:21], v18, s[12:15], 0 offen offset:64
    s_nop 1
    v_cvt_pk_bf16_f32 v20, v100, v101
    v_cvt_pk_bf16_f32 v21, v102, v103
    buffer_store_dwordx2 v[20:21], v18, s[12:15], 0 offen offset:80
    s_nop 1
    v_cvt_pk_bf16_f32 v20, v104, v105
    v_cvt_pk_bf16_f32 v21, v106, v107
    buffer_store_dwordx2 v[20:21], v18, s[12:15], 0 offen offset:96
    s_nop 1
    v_cvt_pk_bf16_f32 v20, v108, v109
    v_cvt_pk_bf16_f32 v21, v110, v111
    buffer_store_dwordx2 v[20:21], v18, s[12:15], 0 offen offset:112
    s_nop 1
    v_cvt_pk_bf16_f32 v20, v112, v113
    v_cvt_pk_bf16_f32 v21, v114, v115
    s_lshl_b32 s59, s50, 5
    buffer_store_dwordx2 v[20:21], v18, s[12:15], s59 offen offset:64
    s_nop 1
    v_cvt_pk_bf16_f32 v20, v116, v117
    v_cvt_pk_bf16_f32 v21, v118, v119
    s_lshl_b32 s59, s50, 5
    buffer_store_dwordx2 v[20:21], v18, s[12:15], s59 offen offset:80
    s_nop 1
    v_cvt_pk_bf16_f32 v20, v120, v121
    v_cvt_pk_bf16_f32 v21, v122, v123
    s_lshl_b32 s59, s50, 5
    buffer_store_dwordx2 v[20:21], v18, s[12:15], s59 offen offset:96
    s_nop 1
    v_cvt_pk_bf16_f32 v20, v124, v125
    v_cvt_pk_bf16_f32 v21, v126, v127
    s_lshl_b32 s59, s50, 5
    buffer_store_dwordx2 v[20:21], v18, s[12:15], s59 offen offset:112
    s_nop 1
opdone_30:
    s_endpgm

.section .rodata,"a"
.p2align 6
.amdhsa_kernel proj_kernel
  .amdhsa_next_free_vgpr 160
  .amdhsa_next_free_sgpr 64
  .amdhsa_accum_offset 160
  .amdhsa_group_segment_fixed_size 0
  .amdhsa_kernarg_size 128
  .amdhsa_user_sgpr_count 2
  .amdhsa_user_sgpr_kernarg_segment_ptr 1
  .amdhsa_system_sgpr_workgroup_id_x 1
.end_amdhsa_kernel
.p2align 6
.amdhsa_kernel chain_kernel
  .amdhsa_next_free_vgpr 512
  .amdhsa_next_free_sgpr 80
  .amdhsa_accum_offset 256
  .amdhsa_group_segment_fixed_size 0
  .amdhsa_kernarg_size 128
  .amdhsa_user_sgpr_count 2
  .amdhsa_user_sgpr_kernarg_segment_ptr 1
  .amdhsa_system_sgpr_workgroup_id_x 1
.end_amdhsa_kernel
.p2align 6
.amdhsa_kernel attna_kernel
  .amdhsa_next_free_vgpr 320
  .amdhsa_next_free_sgpr 80
  .amdhsa_accum_offset 256
  .amdhsa_group_segment_fixed_size 0
  .amdhsa_kernarg_size 128
  .amdhsa_user_sgpr_count 2
  .amdhsa_user_sgpr_kernarg_segment_ptr 1
  .amdhsa_system_sgpr_workgroup_id_x 1
.end_amdhsa_kernel
.p2align 6
.amdhsa_kernel oproj_kernel
  .amdhsa_next_free_vgpr 160
  .amdhsa_next_free_sgpr 64
  .amdhsa_accum_offset 160
  .amdhsa_group_segment_fixed_size 0
  .amdhsa_kernarg_size 128
  .amdhsa_user_sgpr_count 2
  .amdhsa_user_sgpr_kernarg_segment_ptr 1
  .amdhsa_system_sgpr_workgroup_id_x 1
.end_amdhsa_kernel
```
